```python
import torch

def _softmax(x, axis=-1):
    return torch.softmax(x, dim=axis)
def _gelu(x):
    return torch.nn.functional.gelu(x, approximate="tanh")
def _silu(x):
    return torch.nn.functional.silu(x)
def _sigmoid(x):
    return torch.sigmoid(x)
def _layernorm(x, axis=-1, eps=1e-5):
    m = x.mean(dim=axis, keepdim=True)
    v = x.var(dim=axis, keepdim=True, unbiased=False)
    return (x - m) / torch.sqrt(v + eps)
def _scatter_add(tgt, idx, src, axis=0):
    return tgt.clone().index_add_(axis, idx, src)
def _segment_sum(src, seg, n):
    out = torch.zeros((n,) + src.shape[1:], dtype=src.dtype)
    return out.index_add_(0, seg, src)
def _pad(x, pw):
    flat = tuple(v for pair in reversed(pw) for v in pair)
    return torch.nn.functional.pad(x, flat)

kernel_name = 'standalone__mha_softmax__sampling'

def setup_inputs():

    _w = (lambda a: (lambda t: t.to(torch.bfloat16) if t.is_floating_point() else t)(torch.as_tensor(a)))
    B, H, Sq, Sk, D = 8, 16, 4, 4096, 256
    return {
        "q": _w((lambda *s: torch.randn(*s, dtype=torch.bfloat16) * 0.8)(B, H, Sq, D)),
        "k": _w((lambda *s: torch.randn(*s, dtype=torch.bfloat16) * 0.8)(B, H, Sk, D)),
        "v": _w((lambda *s: torch.randn(*s, dtype=torch.bfloat16) * 0.05)(B, H, Sk, D)),
    }

def reference(q, k, v):
    scale = q.shape[-1] ** -0.5
    scores = torch.einsum("bhqd,bhkd->bhqk", q, k) * scale
    p = _softmax(scores, axis=-1)
    return torch.einsum("bhqk,bhkd->bhqd", p, v)
```

```asm
; @launch grid=(256,1,1) block=(256,1,1) lds=25600
.amdgcn_target "amdgcn-amd-amdhsa--gfx950"
.text
.globl standalone__mha_softmax__sampling_kernel
.p2align 8
.type standalone__mha_softmax__sampling_kernel,@function
standalone__mha_softmax__sampling_kernel:
    s_load_dwordx8 s[4:11], s[0:1], 0
    s_load_dwordx4 s[12:15], s[0:1], 32
    s_cmp_ge_u32 s2, 256
    s_cbranch_scc1 L_end
    s_bfe_u32 s3, s2, 0x10001
    s_and_b32 s32, s2, 1
    s_lshl_b32 s32, s32, 1
    s_or_b32 s3, s3, s32
    s_and_b32 s2, s2, 0xfc
    s_or_b32 s2, s2, s3
    v_lshrrev_b32 v102, 6, v0
    v_and_b32 v104, 63, v0
    v_readfirstlane_b32 s30, v102
    v_bfe_u32 v102, v0, 2, 1
    v_lshlrev_b32 v1, 10, v102
    v_bfe_u32 v102, v0, 1, 1
    v_lshl_add_u32 v1, v102, 13, v1
    v_bfe_u32 v102, v0, 3, 1
    v_lshl_add_u32 v1, v102, 9, v1
    v_bfe_u32 v103, v0, 4, 2
    v_lshl_add_u32 v1, v103, 5, v1
    v_and_b32 v102, 1, v0
    v_lshl_add_u32 v1, v102, 4, v1
    v_lshlrev_b32 v2, 4, v104
    v_add_u32 v3, 8192, v2
    v_and_b32 v102, 3, v0
    v_lshlrev_b32 v105, 9, v102
    v_lshl_add_u32 v105, v103, 5, v105
    v_bfe_u32 v102, v0, 2, 1
    v_lshl_add_u32 v105, v102, 4, v105
    s_lshr_b32 s31, s2, 1
    s_lshl_b32 s3, s31, 11
    v_add_u32 v102, s3, v2
    s_lshl_b32 s3, s30, 11
    s_add_u32 s3, s3, 17408
    s_mov_b32 m0, s3
    v_add_u32 v105, s3, v105
    s_lshl_b32 s24, s31, 21
    s_and_b32 s3, s2, 1
    s_lshl_b32 s3, s3, 14
    s_or_b32 s24, s24, s3
    s_and_b32 s3, s30, 1
    s_lshl_b32 s3, s3, 12
    s_or_b32 s24, s24, s3
    s_lshr_b32 s3, s30, 1
    s_lshl_b32 s3, s3, 15
    s_or_b32 s24, s24, s3
    s_mov_b32 s25, s24
    s_mov_b32 s18, 0x10000000
    s_mov_b32 s19, 0x20000
    s_mov_b32 s22, 0x10000000
    s_mov_b32 s23, 0x20000
    s_waitcnt lgkmcnt(0)
    s_mov_b32 s16, s6
    s_and_b32 s17, s7, 0xffff
    buffer_load_dwordx4 v[116:119], v1, s[16:19], s24 offen offset:0 nt
    buffer_load_dwordx4 v[120:123], v1, s[16:19], s24 offen offset:128 nt
    buffer_load_dwordx4 v[124:127], v1, s[16:19], s24 offen offset:256 nt
    buffer_load_dwordx4 v[128:131], v1, s[16:19], s24 offen offset:384 nt
    buffer_load_dwordx4 v[132:135], v1, s[16:19], s24 offen offset:2048 nt
    global_load_lds_dwordx4 v102, s[4:5] nt
    global_load_lds_dwordx4 v102, s[4:5] offset:1024 nt
    s_mov_b32 s20, s8
    s_and_b32 s21, s9, 0xffff
    s_mov_b32 s27, 0x3db8aa3b
    s_mov_b32 s28, 0x05040100
    s_mov_b32 s29, 0x07060302
    s_lshl_b32 s3, s2, 13
    s_lshl_b32 s32, s30, 11
    s_add_u32 s32, s32, s3
    v_add_u32 v107, s32, v2
    v_xor_b32 v109, 8192, v107
    v_mov_b32 v112, s32
    v_xor_b32 v113, 8192, v112
    s_andn2_b32 s3, s32, 8192
    s_add_u32 s41, s3, 1040
    v_mov_b32 v108, s41
    s_lshl_b32 s3, s31, 11
    s_lshl_b32 s32, s30, 9
    s_add_u32 s3, s3, s32
    v_lshl_add_u32 v110, v104, 3, s3
    s_and_b32 s39, s2, 7
    s_mul_i32 s39, s39, 3
    s_lshr_b32 s38, s2, 3
    s_mov_b32 s37, 0x600000
    s_mov_b32 s35, 1
    s_cmp_eq_u32 s30, 0
    s_cselect_b32 s36, 0x2924, 0
    s_mov_b32 s34, 0xff
    v_mov_b32 v114, 16640
    v_mov_b32 v103, s34
    ds_write_b32 v114, v103
    v_mov_b32 v52, 0
    v_mov_b32 v53, 0
    v_mov_b32 v54, 0
    v_mov_b32 v55, 0
    v_mov_b32 v56, 0
    v_mov_b32 v57, 0
    v_mov_b32 v58, 0
    v_mov_b32 v59, 0
    v_mov_b32 v60, 0
    v_mov_b32 v61, 0
    v_mov_b32 v62, 0
    v_mov_b32 v63, 0
    v_mov_b32 v64, 0
    v_mov_b32 v65, 0
    v_mov_b32 v66, 0
    v_mov_b32 v67, 0
    v_mov_b32 v68, 0
    v_mov_b32 v69, 0
    v_mov_b32 v70, 0
    v_mov_b32 v71, 0
    v_mov_b32 v72, 0
    v_mov_b32 v73, 0
    v_mov_b32 v74, 0
    v_mov_b32 v75, 0
    v_mov_b32 v76, 0
    v_mov_b32 v77, 0
    v_mov_b32 v78, 0
    v_mov_b32 v79, 0
    v_mov_b32 v80, 0
    v_mov_b32 v81, 0
    v_mov_b32 v82, 0
    v_mov_b32 v83, 0
    s_waitcnt vmcnt(6)
    buffer_load_dwordx4 v[136:139], v1, s[16:19], s24 offen offset:2176 nt
    s_waitcnt vmcnt(6)
    buffer_load_dwordx4 v[140:143], v1, s[16:19], s24 offen offset:2304 nt
    s_waitcnt vmcnt(6)
    buffer_load_dwordx4 v[144:147], v1, s[16:19], s24 offen offset:2432 nt
    s_add_u32 s24, s24, 65536
    s_waitcnt vmcnt(6)
    buffer_load_dwordx4 v[148:151], v1, s[16:19], s24 offen offset:0 nt
    s_waitcnt vmcnt(6)
    buffer_load_dwordx4 v[152:155], v1, s[16:19], s24 offen offset:128 nt
    s_waitcnt vmcnt(5)
    s_bitcmp1_b32 s34, 0
    s_cbranch_scc1 L_w1
    s_waitcnt vmcnt(4)
L_w1:
    buffer_load_dwordx4 v[156:159], v1, s[16:19], s24 offen offset:256 nt
    ds_read_b128 v[4:7], v105 offset:0
    ds_read_b128 v[8:11], v105 offset:128
    ds_read_b128 v[12:15], v105 offset:256
    ds_read_b128 v[16:19], v105 offset:384
    s_waitcnt vmcnt(4)
    buffer_load_dwordx4 v[160:163], v1, s[16:19], s24 offen offset:384 nt
    s_waitcnt lgkmcnt(0)
    v_mfma_f32_16x16x32_bf16 v[84:87], v[116:119], v[4:7], 0
    v_mfma_f32_16x16x32_bf16 v[84:87], v[120:123], v[8:11], v[84:87]
    s_cmp_lg_u32 s30, 0
    s_cbranch_scc1 L_b2
    s_mov_b32 s32, s38
    s_mul_i32 s3, s32, 8320
    s_add_u32 s3, s3, 0x600000
    s_load_dword s44, s[14:15], s3
    s_add_u32 s32, s32, s39
    s_and_b32 s32, s32, 31
    s_mul_i32 s3, s32, 8320
    s_add_u32 s3, s3, 0x641000
    s_load_dword s45, s[14:15], s3
    s_add_u32 s32, s32, s39
    s_and_b32 s32, s32, 31
    s_mul_i32 s3, s32, 8320
    s_add_u32 s3, s3, 0x682000
    s_load_dword s46, s[14:15], s3
    s_add_u32 s32, s32, s39
    s_and_b32 s32, s32, 31
    s_mul_i32 s3, s32, 8320
    s_add_u32 s3, s3, 0x6c3000
    s_load_dword s47, s[14:15], s3
    s_add_u32 s32, s32, s39
    s_and_b32 s32, s32, 31
    s_mul_i32 s3, s32, 8320
    s_add_u32 s3, s3, 0x704000
    s_load_dword s48, s[14:15], s3
    s_add_u32 s32, s32, s39
    s_and_b32 s32, s32, 31
L_b2:
    s_waitcnt vmcnt(4)
    buffer_load_dwordx4 v[164:167], v1, s[16:19], s24 offen offset:2048 nt
    v_mfma_f32_16x16x32_bf16 v[84:87], v[124:127], v[12:15], v[84:87]
    s_load_dword s42, s[14:15], s41
    s_waitcnt vmcnt(4)
    buffer_load_dwordx4 v[168:171], v1, s[16:19], s24 offen offset:2176 nt
    v_mfma_f32_16x16x32_bf16 v[84:87], v[128:131], v[16:19], v[84:87]
    s_waitcnt vmcnt(5)
    s_bitcmp1_b32 s34, 4
    s_cbranch_scc1 L_w3
    s_waitcnt vmcnt(4)
L_w3:
    buffer_load_dwordx4 v[172:175], v1, s[16:19], s24 offen offset:2304 nt
    v_mfma_f32_16x16x32_bf16 v[88:91], v[132:135], v[4:7], 0
    s_waitcnt vmcnt(4)
    buffer_load_dwordx4 v[176:179], v1, s[16:19], s24 offen offset:2432 nt
    s_add_u32 s24, s24, 65536
    v_mfma_f32_16x16x32_bf16 v[88:91], v[136:139], v[8:11], v[88:91]
    s_waitcnt vmcnt(4)
    buffer_load_dwordx4 v[180:183], v1, s[16:19], s24 offen offset:0 nt
    v_mfma_f32_16x16x32_bf16 v[88:91], v[140:143], v[12:15], v[88:91]
    s_waitcnt vmcnt(4)
    buffer_load_dwordx4 v[184:187], v1, s[16:19], s24 offen offset:128 nt
    v_mfma_f32_16x16x32_bf16 v[88:91], v[144:147], v[16:19], v[88:91]
    v_add_f32_dpp v48, v85, v84 row_ror:4 row_mask:0xf bank_mask:0x1
    v_add_f32_dpp v49, v87, v86 row_ror:4 row_mask:0xf bank_mask:0x1
    s_nop 5
    v_add_f32_dpp v50, v89, v88 row_ror:4 row_mask:0xf bank_mask:0x1
    v_add_f32_dpp v51, v91, v90 row_ror:4 row_mask:0xf bank_mask:0x1
    s_waitcnt vmcnt(5)
    s_bitcmp1_b32 s34, 2
    s_cbranch_scc1 L_w4
    s_waitcnt vmcnt(4)
L_w4:
    buffer_load_dwordx4 v[188:191], v1, s[16:19], s24 offen offset:256 nt
    v_mfma_f32_16x16x32_bf16 v[84:87], v[148:151], v[4:7], 0
    s_waitcnt vmcnt(4)
    buffer_load_dwordx4 v[192:195], v1, s[16:19], s24 offen offset:384 nt
    v_mfma_f32_16x16x32_bf16 v[84:87], v[152:155], v[8:11], v[84:87]
    s_waitcnt vmcnt(4)
    buffer_load_dwordx4 v[196:199], v1, s[16:19], s24 offen offset:2048 nt
    v_mfma_f32_16x16x32_bf16 v[84:87], v[156:159], v[12:15], v[84:87]
    s_waitcnt vmcnt(4)
    buffer_load_dwordx4 v[200:203], v1, s[16:19], s24 offen offset:2176 nt
    v_mfma_f32_16x16x32_bf16 v[84:87], v[160:163], v[16:19], v[84:87]
    s_waitcnt vmcnt(5)
    s_bitcmp1_b32 s34, 6
    s_cbranch_scc1 L_w5
    s_waitcnt vmcnt(4)
L_w5:
    buffer_load_dwordx4 v[204:207], v1, s[16:19], s24 offen offset:2304 nt
    v_mfma_f32_16x16x32_bf16 v[88:91], v[164:167], v[4:7], 0
    s_waitcnt vmcnt(4)
    buffer_load_dwordx4 v[208:211], v1, s[16:19], s24 offen offset:2432 nt
    s_add_u32 s24, s24, 65536
    v_mfma_f32_16x16x32_bf16 v[88:91], v[168:171], v[8:11], v[88:91]
    s_waitcnt vmcnt(4)
    buffer_load_dwordx4 v[212:215], v1, s[16:19], s24 offen offset:0 nt
    v_mfma_f32_16x16x32_bf16 v[88:91], v[172:175], v[12:15], v[88:91]
    s_waitcnt vmcnt(4)
    buffer_load_dwordx4 v[216:219], v1, s[16:19], s24 offen offset:128 nt
    v_mfma_f32_16x16x32_bf16 v[88:91], v[176:179], v[16:19], v[88:91]
    v_add_f32_dpp v48, v84, v85 row_ror:4 row_mask:0xf bank_mask:0x2
    v_add_f32_dpp v49, v86, v87 row_ror:4 row_mask:0xf bank_mask:0x2
    s_nop 5
    v_add_f32_dpp v50, v88, v89 row_ror:4 row_mask:0xf bank_mask:0x2
    v_add_f32_dpp v51, v90, v91 row_ror:4 row_mask:0xf bank_mask:0x2
    s_waitcnt vmcnt(5)
    s_bitcmp1_b32 s34, 1
    s_cbranch_scc1 L_w6
    s_waitcnt vmcnt(4)
L_w6:
    buffer_load_dwordx4 v[220:223], v1, s[16:19], s24 offen offset:256 nt
    v_mfma_f32_16x16x32_bf16 v[84:87], v[180:183], v[4:7], 0
    s_waitcnt vmcnt(4)
    buffer_load_dwordx4 v[224:227], v1, s[16:19], s24 offen offset:384 nt
    v_mfma_f32_16x16x32_bf16 v[84:87], v[184:187], v[8:11], v[84:87]
    s_waitcnt vmcnt(4)
    buffer_load_dwordx4 v[228:231], v1, s[16:19], s24 offen offset:2048 nt
    v_mfma_f32_16x16x32_bf16 v[84:87], v[188:191], v[12:15], v[84:87]
    s_waitcnt vmcnt(4)
    buffer_load_dwordx4 v[232:235], v1, s[16:19], s24 offen offset:2176 nt
    v_mfma_f32_16x16x32_bf16 v[84:87], v[192:195], v[16:19], v[84:87]
    s_waitcnt vmcnt(5)
    s_bitcmp1_b32 s34, 5
    s_cbranch_scc1 L_w7
    s_waitcnt vmcnt(4)
L_w7:
    buffer_load_dwordx4 v[236:239], v1, s[16:19], s24 offen offset:2304 nt
    v_mfma_f32_16x16x32_bf16 v[88:91], v[196:199], v[4:7], 0
    s_waitcnt vmcnt(4)
    buffer_load_dwordx4 v[240:243], v1, s[16:19], s24 offen offset:2432 nt
    s_add_u32 s24, s24, 65536
    v_mfma_f32_16x16x32_bf16 v[88:91], v[200:203], v[8:11], v[88:91]
    s_waitcnt vmcnt(4)
    buffer_load_dwordx4 v[116:119], v1, s[16:19], s24 offen offset:0 nt
    v_mfma_f32_16x16x32_bf16 v[88:91], v[204:207], v[12:15], v[88:91]
    s_waitcnt vmcnt(4)
    buffer_load_dwordx4 v[120:123], v1, s[16:19], s24 offen offset:128 nt
    v_mfma_f32_16x16x32_bf16 v[88:91], v[208:211], v[16:19], v[88:91]
    v_add_f32_dpp v48, v85, v84 row_ror:4 row_mask:0xf bank_mask:0x4
    v_add_f32_dpp v49, v87, v86 row_ror:4 row_mask:0xf bank_mask:0x4
    s_nop 5
    v_add_f32_dpp v50, v89, v88 row_ror:4 row_mask:0xf bank_mask:0x4
    v_add_f32_dpp v51, v91, v90 row_ror:4 row_mask:0xf bank_mask:0x4
    s_waitcnt vmcnt(5)
    s_bitcmp1_b32 s34, 3
    s_cbranch_scc1 L_w8
    s_waitcnt vmcnt(4)
L_w8:
    buffer_load_dwordx4 v[124:127], v1, s[16:19], s24 offen offset:256 nt
    v_mfma_f32_16x16x32_bf16 v[84:87], v[212:215], v[4:7], 0
    s_waitcnt vmcnt(4)
    buffer_load_dwordx4 v[128:131], v1, s[16:19], s24 offen offset:384 nt
    v_mfma_f32_16x16x32_bf16 v[84:87], v[216:219], v[8:11], v[84:87]
    s_waitcnt vmcnt(4)
    buffer_load_dwordx4 v[132:135], v1, s[16:19], s24 offen offset:2048 nt
    v_mfma_f32_16x16x32_bf16 v[84:87], v[220:223], v[12:15], v[84:87]
    s_waitcnt vmcnt(4)
    buffer_load_dwordx4 v[136:139], v1, s[16:19], s24 offen offset:2176 nt
    v_mfma_f32_16x16x32_bf16 v[84:87], v[224:227], v[16:19], v[84:87]
    s_waitcnt vmcnt(5)
    s_bitcmp1_b32 s34, 7
    s_cbranch_scc1 L_w9
    s_waitcnt vmcnt(4)
L_w9:
    buffer_load_dwordx4 v[140:143], v1, s[16:19], s24 offen offset:2304 nt
    v_mfma_f32_16x16x32_bf16 v[88:91], v[228:231], v[4:7], 0
    s_waitcnt vmcnt(4)
    buffer_load_dwordx4 v[144:147], v1, s[16:19], s24 offen offset:2432 nt
    s_add_u32 s24, s24, 65536
    v_mfma_f32_16x16x32_bf16 v[88:91], v[232:235], v[8:11], v[88:91]
    s_waitcnt vmcnt(4)
    buffer_load_dwordx4 v[148:151], v1, s[16:19], s24 offen offset:0 nt
    v_mfma_f32_16x16x32_bf16 v[88:91], v[236:239], v[12:15], v[88:91]
    s_waitcnt vmcnt(4)
    buffer_load_dwordx4 v[152:155], v1, s[16:19], s24 offen offset:128 nt
    v_mfma_f32_16x16x32_bf16 v[88:91], v[240:243], v[16:19], v[88:91]
    v_add_f32_dpp v48, v84, v85 row_ror:4 row_mask:0xf bank_mask:0x8
    v_add_f32_dpp v49, v86, v87 row_ror:4 row_mask:0xf bank_mask:0x8
    s_nop 5
    v_add_f32_dpp v50, v88, v89 row_ror:4 row_mask:0xf bank_mask:0x8
    v_add_f32_dpp v51, v90, v91 row_ror:4 row_mask:0xf bank_mask:0x8
    s_mov_b32 s26, 6
L_kb:
    s_waitcnt vmcnt(5)
    s_bitcmp1_b32 s34, 0
    s_cbranch_scc1 L_w10
    s_waitcnt vmcnt(4)
L_w10:
    buffer_load_dwordx4 v[156:159], v1, s[16:19], s24 offen offset:256 nt
    s_bitcmp1_b32 s36, s35
    s_cbranch_scc0 L_r11
    s_mul_i32 s3, s38, 8320
    s_add_u32 s3, s3, s37
    s_mov_b32 s40, 1
    s_atomic_add s40, s[14:15], s3 glc
    s_add_u32 s37, s37, 266240
    s_add_u32 s38, s38, s39
    s_and_b32 s38, s38, 31
L_r11:
    v_mov_b32 v20, v24
    v_mov_b32 v21, v25
    v_mov_b32 v22, v26
    v_mov_b32 v23, v27
    v_mfma_f32_16x16x32_bf16 v[84:87], v[116:119], v[4:7], 0
    s_waitcnt vmcnt(5)
    s_bitcmp1_b32 s34, 16
    s_cbranch_scc1 L_w12
    s_waitcnt vmcnt(4)
L_w12:
    buffer_load_dwordx4 v[160:163], v1, s[16:19], s24 offen offset:384 nt
    v_mov_b32 v24, v28
    v_mov_b32 v25, v29
    v_mov_b32 v26, v30
    v_mov_b32 v27, v31
    v_mfma_f32_16x16x32_bf16 v[84:87], v[120:123], v[8:11], v[84:87]
    s_waitcnt vmcnt(5)
    s_bitcmp1_b32 s34, 8
    s_cbranch_scc1 L_w13
    s_waitcnt vmcnt(4)
L_w13:
    buffer_load_dwordx4 v[164:167], v1, s[16:19], s24 offen offset:2048 nt
    v_mov_b32 v28, v32
    v_mov_b32 v29, v33
    v_mov_b32 v30, v34
    v_mov_b32 v31, v35
    v_mfma_f32_16x16x32_bf16 v[84:87], v[124:127], v[12:15], v[84:87]
    s_waitcnt vmcnt(5)
    s_bitcmp1_b32 s34, 24
    s_cbranch_scc1 L_w14
    s_waitcnt vmcnt(4)
L_w14:
    buffer_load_dwordx4 v[168:171], v1, s[16:19], s24 offen offset:2176 nt
    v_mov_b32 v32, v36
    v_mov_b32 v33, v37
    v_mov_b32 v34, v38
    v_mov_b32 v35, v39
    v_mfma_f32_16x16x32_bf16 v[84:87], v[128:131], v[16:19], v[84:87]
    s_waitcnt vmcnt(5)
    s_bitcmp1_b32 s34, 4
    s_cbranch_scc1 L_w15
    s_waitcnt vmcnt(4)
L_w15:
    buffer_load_dwordx4 v[172:175], v1, s[16:19], s24 offen offset:2304 nt
    v_mov_b32 v36, v40
    v_mov_b32 v37, v41
    v_mov_b32 v38, v42
    v_mov_b32 v39, v43
    v_mfma_f32_16x16x32_bf16 v[88:91], v[132:135], v[4:7], 0
    s_waitcnt vmcnt(5)
    s_bitcmp1_b32 s34, 20
    s_cbranch_scc1 L_w16
    s_waitcnt vmcnt(4)
L_w16:
    buffer_load_dwordx4 v[176:179], v1, s[16:19], s24 offen offset:2432 nt
    s_add_u32 s24, s24, 65536
    v_mov_b32 v40, v44
    v_mov_b32 v41, v45
    v_mov_b32 v42, v46
    v_mov_b32 v43, v47
    v_mfma_f32_16x16x32_bf16 v[88:91], v[136:139], v[8:11], v[88:91]
    s_waitcnt vmcnt(5)
    s_bitcmp1_b32 s34, 12
    s_cbranch_scc1 L_w17
    s_waitcnt vmcnt(4)
L_w17:
    buffer_load_dwordx4 v[180:183], v1, s[16:19], s24 offen offset:0 nt
    v_mov_b32 v44, v48
    v_mov_b32 v45, v49
    v_mov_b32 v46, v50
    v_mov_b32 v47, v51
    v_mfma_f32_16x16x32_bf16 v[88:91], v[140:143], v[12:15], v[88:91]
    s_waitcnt vmcnt(5)
    s_bitcmp1_b32 s34, 28
    s_cbranch_scc1 L_w18
    s_waitcnt vmcnt(4)
L_w18:
    buffer_load_dwordx4 v[184:187], v1, s[16:19], s24 offen offset:128 nt
    v_mfma_f32_16x16x32_bf16 v[88:91], v[144:147], v[16:19], v[88:91]
    v_add_f32_dpp v48, v85, v84 row_ror:4 row_mask:0xf bank_mask:0x1
    v_add_f32_dpp v49, v87, v86 row_ror:4 row_mask:0xf bank_mask:0x1
    s_nop 5
    v_add_f32_dpp v50, v89, v88 row_ror:4 row_mask:0xf bank_mask:0x1
    v_add_f32_dpp v51, v91, v90 row_ror:4 row_mask:0xf bank_mask:0x1
    s_waitcnt vmcnt(5)
    s_bitcmp1_b32 s34, 2
    s_cbranch_scc1 L_w19
    s_waitcnt vmcnt(4)
L_w19:
    buffer_load_dwordx4 v[188:191], v1, s[16:19], s24 offen offset:256 nt
    s_bitcmp1_b32 s36, s35
    s_cbranch_scc0 L_r20
    s_waitcnt lgkmcnt(0)
    s_sub_u32 s3, s40, s44
    s_mov_b32 s44, s45
    s_mov_b32 s45, s46
    s_mov_b32 s46, s47
    s_mov_b32 s47, s48
    s_max_i32 s3, s3, 0
    s_min_u32 s3, s3, 7
    s_lshl_b32 s3, s3, 3
    s_mov_b32 s32, 0x4020000
    s_mov_b32 s33, 0x20160e08
    s_lshr_b64 s[32:33], s[32:33], s3
    s_and_b32 s3, s32, 63
    s_bfm_b64 s[32:33], s3, 0
    v_mov_b32 v102, s32
    ds_write_b32 v114, v102
L_r20:
    v_mfma_f32_16x16x32_bf16 v[84:87], v[148:151], v[4:7], 0
    s_waitcnt vmcnt(5)
    s_bitcmp1_b32 s34, 18
    s_cbranch_scc1 L_w21
    s_waitcnt vmcnt(4)
L_w21:
    buffer_load_dwordx4 v[192:195], v1, s[16:19], s24 offen offset:384 nt
    v_mfma_f32_16x16x32_bf16 v[84:87], v[152:155], v[8:11], v[84:87]
    s_waitcnt vmcnt(5)
    s_bitcmp1_b32 s34, 10
    s_cbranch_scc1 L_w22
    s_waitcnt vmcnt(4)
L_w22:
    buffer_load_dwordx4 v[196:199], v1, s[16:19], s24 offen offset:2048 nt
    v_mfma_f32_16x16x32_bf16 v[84:87], v[156:159], v[12:15], v[84:87]
    s_waitcnt vmcnt(5)
    s_bitcmp1_b32 s34, 26
    s_cbranch_scc1 L_w23
    s_waitcnt vmcnt(4)
L_w23:
    buffer_load_dwordx4 v[200:203], v1, s[16:19], s24 offen offset:2176 nt
    v_mfma_f32_16x16x32_bf16 v[84:87], v[160:163], v[16:19], v[84:87]
    s_waitcnt vmcnt(5)
    s_bitcmp1_b32 s34, 6
    s_cbranch_scc1 L_w24
    s_waitcnt vmcnt(4)
L_w24:
    buffer_load_dwordx4 v[204:207], v1, s[16:19], s24 offen offset:2304 nt
    ds_read_b32 v103, v114
    v_mfma_f32_16x16x32_bf16 v[88:91], v[164:167], v[4:7], 0
    s_waitcnt vmcnt(5)
    s_bitcmp1_b32 s34, 22
    s_cbranch_scc1 L_w25
    s_waitcnt vmcnt(4)
L_w25:
    buffer_load_dwordx4 v[208:211], v1, s[16:19], s24 offen offset:2432 nt
    s_add_u32 s24, s24, 65536
    v_mfma_f32_16x16x32_bf16 v[88:91], v[168:171], v[8:11], v[88:91]
    s_waitcnt vmcnt(5)
    s_bitcmp1_b32 s34, 14
    s_cbranch_scc1 L_w26
    s_waitcnt vmcnt(4)
L_w26:
    buffer_load_dwordx4 v[212:215], v1, s[16:19], s24 offen offset:0 nt
    s_waitcnt lgkmcnt(0)
    v_readfirstlane_b32 s34, v103
    v_mfma_f32_16x16x32_bf16 v[88:91], v[172:175], v[12:15], v[88:91]
    s_waitcnt vmcnt(5)
    s_bitcmp1_b32 s34, 30
    s_cbranch_scc1 L_w27
    s_waitcnt vmcnt(4)
L_w27:
    buffer_load_dwordx4 v[216:219], v1, s[16:19], s24 offen offset:128 nt
    v_mfma_f32_16x16x32_bf16 v[88:91], v[176:179], v[16:19], v[88:91]
    v_add_f32_dpp v48, v84, v85 row_ror:4 row_mask:0xf bank_mask:0x2
    v_add_f32_dpp v49, v86, v87 row_ror:4 row_mask:0xf bank_mask:0x2
    s_nop 5
    v_add_f32_dpp v50, v88, v89 row_ror:4 row_mask:0xf bank_mask:0x2
    v_add_f32_dpp v51, v90, v91 row_ror:4 row_mask:0xf bank_mask:0x2
    s_waitcnt vmcnt(5)
    s_bitcmp1_b32 s34, 1
    s_cbranch_scc1 L_w28
    s_waitcnt vmcnt(4)
L_w28:
    buffer_load_dwordx4 v[220:223], v1, s[16:19], s24 offen offset:256 nt
    v_mfma_f32_16x16x32_bf16 v[84:87], v[180:183], v[4:7], 0
    s_waitcnt vmcnt(5)
    s_bitcmp1_b32 s34, 17
    s_cbranch_scc1 L_w29
    s_waitcnt vmcnt(4)
L_w29:
    buffer_load_dwordx4 v[224:227], v1, s[16:19], s24 offen offset:384 nt
    v_mfma_f32_16x16x32_bf16 v[84:87], v[184:187], v[8:11], v[84:87]
    s_waitcnt vmcnt(5)
    s_bitcmp1_b32 s34, 9
    s_cbranch_scc1 L_w30
    s_waitcnt vmcnt(4)
L_w30:
    buffer_load_dwordx4 v[228:231], v1, s[16:19], s24 offen offset:2048 nt
    v_mfma_f32_16x16x32_bf16 v[84:87], v[188:191], v[12:15], v[84:87]
    s_waitcnt vmcnt(5)
    s_bitcmp1_b32 s34, 25
    s_cbranch_scc1 L_w31
    s_waitcnt vmcnt(4)
L_w31:
    buffer_load_dwordx4 v[232:235], v1, s[16:19], s24 offen offset:2176 nt
    v_mfma_f32_16x16x32_bf16 v[84:87], v[192:195], v[16:19], v[84:87]
    s_waitcnt vmcnt(5)
    s_bitcmp1_b32 s34, 5
    s_cbranch_scc1 L_w32
    s_waitcnt vmcnt(4)
L_w32:
    buffer_load_dwordx4 v[236:239], v1, s[16:19], s24 offen offset:2304 nt
    ds_read_b32 v103, v114
    v_mfma_f32_16x16x32_bf16 v[88:91], v[196:199], v[4:7], 0
    s_waitcnt vmcnt(5)
    s_bitcmp1_b32 s34, 21
    s_cbranch_scc1 L_w33
    s_waitcnt vmcnt(4)
L_w33:
    buffer_load_dwordx4 v[240:243], v1, s[16:19], s24 offen offset:2432 nt
    s_add_u32 s24, s24, 65536
    v_mfma_f32_16x16x32_bf16 v[88:91], v[200:203], v[8:11], v[88:91]
    s_waitcnt vmcnt(5)
    s_bitcmp1_b32 s34, 13
    s_cbranch_scc1 L_w34
    s_waitcnt vmcnt(4)
L_w34:
    buffer_load_dwordx4 v[116:119], v1, s[16:19], s24 offen offset:0 nt
    s_waitcnt lgkmcnt(0)
    v_readfirstlane_b32 s34, v103
    v_mfma_f32_16x16x32_bf16 v[88:91], v[204:207], v[12:15], v[88:91]
    s_waitcnt vmcnt(5)
    s_bitcmp1_b32 s34, 29
    s_cbranch_scc1 L_w35
    s_waitcnt vmcnt(4)
L_w35:
    buffer_load_dwordx4 v[120:123], v1, s[16:19], s24 offen offset:128 nt
    v_mfma_f32_16x16x32_bf16 v[88:91], v[208:211], v[16:19], v[88:91]
    v_add_f32_dpp v48, v85, v84 row_ror:4 row_mask:0xf bank_mask:0x4
    v_add_f32_dpp v49, v87, v86 row_ror:4 row_mask:0xf bank_mask:0x4
    s_nop 5
    v_add_f32_dpp v50, v89, v88 row_ror:4 row_mask:0xf bank_mask:0x4
    v_add_f32_dpp v51, v91, v90 row_ror:4 row_mask:0xf bank_mask:0x4
    s_waitcnt vmcnt(5)
    s_bitcmp1_b32 s34, 3
    s_cbranch_scc1 L_w36
    s_waitcnt vmcnt(4)
L_w36:
    buffer_load_dwordx4 v[124:127], v1, s[16:19], s24 offen offset:256 nt
    v_mfma_f32_16x16x32_bf16 v[84:87], v[212:215], v[4:7], 0
    s_waitcnt vmcnt(5)
    s_bitcmp1_b32 s34, 19
    s_cbranch_scc1 L_w37
    s_waitcnt vmcnt(4)
L_w37:
    buffer_load_dwordx4 v[128:131], v1, s[16:19], s24 offen offset:384 nt
    v_mfma_f32_16x16x32_bf16 v[84:87], v[216:219], v[8:11], v[84:87]
    s_waitcnt vmcnt(5)
    s_bitcmp1_b32 s34, 11
    s_cbranch_scc1 L_w38
    s_waitcnt vmcnt(4)
L_w38:
    buffer_load_dwordx4 v[132:135], v1, s[16:19], s24 offen offset:2048 nt
    v_mfma_f32_16x16x32_bf16 v[84:87], v[220:223], v[12:15], v[84:87]
    s_waitcnt vmcnt(5)
    s_bitcmp1_b32 s34, 27
    s_cbranch_scc1 L_w39
    s_waitcnt vmcnt(4)
L_w39:
    buffer_load_dwordx4 v[136:139], v1, s[16:19], s24 offen offset:2176 nt
    v_mfma_f32_16x16x32_bf16 v[84:87], v[224:227], v[16:19], v[84:87]
    s_waitcnt vmcnt(5)
    s_bitcmp1_b32 s34, 7
    s_cbranch_scc1 L_w40
    s_waitcnt vmcnt(4)
L_w40:
    buffer_load_dwordx4 v[140:143], v1, s[16:19], s24 offen offset:2304 nt
    v_mfma_f32_16x16x32_bf16 v[88:91], v[228:231], v[4:7], 0
    s_waitcnt vmcnt(5)
    s_bitcmp1_b32 s34, 23
    s_cbranch_scc1 L_w41
    s_waitcnt vmcnt(4)
L_w41:
    buffer_load_dwordx4 v[144:147], v1, s[16:19], s24 offen offset:2432 nt
    s_add_u32 s24, s24, 65536
    v_mfma_f32_16x16x32_bf16 v[88:91], v[232:235], v[8:11], v[88:91]
    s_waitcnt vmcnt(5)
    s_bitcmp1_b32 s34, 15
    s_cbranch_scc1 L_w42
    s_waitcnt vmcnt(4)
L_w42:
    buffer_load_dwordx4 v[148:151], v1, s[16:19], s24 offen offset:0 nt
    v_mfma_f32_16x16x32_bf16 v[88:91], v[236:239], v[12:15], v[88:91]
    s_waitcnt vmcnt(5)
    s_bitcmp1_b32 s34, 31
    s_cbranch_scc1 L_w43
    s_waitcnt vmcnt(4)
L_w43:
    buffer_load_dwordx4 v[152:155], v1, s[16:19], s24 offen offset:128 nt
    s_add_u32 s35, s35, 1
    v_mfma_f32_16x16x32_bf16 v[88:91], v[240:243], v[16:19], v[88:91]
    v_add_f32_dpp v48, v84, v85 row_ror:4 row_mask:0xf bank_mask:0x8
    v_add_f32_dpp v49, v86, v87 row_ror:4 row_mask:0xf bank_mask:0x8
    s_nop 5
    v_add_f32_dpp v50, v88, v89 row_ror:4 row_mask:0xf bank_mask:0x8
    v_add_f32_dpp v51, v90, v91 row_ror:4 row_mask:0xf bank_mask:0x8
    s_sub_u32 s26, s26, 1
    s_cmp_lg_u32 s26, 0
    s_cbranch_scc1 L_kb
    s_waitcnt lgkmcnt(0)
    s_add_u32 s42, s42, 0x9e3779b9
    v_mov_b32 v106, s42
    s_waitcnt vmcnt(5)
    s_bitcmp1_b32 s34, 0
    s_cbranch_scc1 L_w44
    s_waitcnt vmcnt(4)
L_w44:
    buffer_load_dwordx4 v[156:159], v1, s[16:19], s24 offen offset:256 nt
    s_bitcmp1_b32 s36, s35
    s_cbranch_scc0 L_r45
    s_mul_i32 s3, s38, 8320
    s_add_u32 s3, s3, s37
    s_mov_b32 s40, 1
    s_atomic_add s40, s[14:15], s3 glc
    s_add_u32 s37, s37, 266240
    s_add_u32 s38, s38, s39
    s_and_b32 s38, s38, 31
L_r45:
    v_mov_b32 v20, v24
    v_mov_b32 v21, v25
    v_mov_b32 v22, v26
    v_mov_b32 v23, v27
    v_mfma_f32_16x16x32_bf16 v[84:87], v[116:119], v[4:7], 0
    s_waitcnt vmcnt(5)
    s_bitcmp1_b32 s34, 16
    s_cbranch_scc1 L_w46
    s_waitcnt vmcnt(4)
L_w46:
    buffer_load_dwordx4 v[160:163], v1, s[16:19], s24 offen offset:384 nt
    v_mov_b32 v24, v28
    v_mov_b32 v25, v29
    v_mov_b32 v26, v30
    v_mov_b32 v27, v31
    v_mfma_f32_16x16x32_bf16 v[84:87], v[120:123], v[8:11], v[84:87]
    s_waitcnt vmcnt(5)
    s_bitcmp1_b32 s34, 8
    s_cbranch_scc1 L_w47
    s_waitcnt vmcnt(4)
L_w47:
    buffer_load_dwordx4 v[164:167], v1, s[16:19], s24 offen offset:2048 nt
    v_mov_b32 v28, v32
    v_mov_b32 v29, v33
    v_mov_b32 v30, v34
    v_mov_b32 v31, v35
    v_mfma_f32_16x16x32_bf16 v[84:87], v[124:127], v[12:15], v[84:87]
    s_waitcnt vmcnt(5)
    s_bitcmp1_b32 s34, 24
    s_cbranch_scc1 L_w48
    s_waitcnt vmcnt(4)
L_w48:
    buffer_load_dwordx4 v[168:171], v1, s[16:19], s24 offen offset:2176 nt
    v_mov_b32 v32, v36
    v_mov_b32 v33, v37
    v_mov_b32 v34, v38
    v_mov_b32 v35, v39
    v_mfma_f32_16x16x32_bf16 v[84:87], v[128:131], v[16:19], v[84:87]
    s_waitcnt vmcnt(5)
    s_bitcmp1_b32 s34, 4
    s_cbranch_scc1 L_w49
    s_waitcnt vmcnt(4)
L_w49:
    buffer_load_dwordx4 v[172:175], v1, s[16:19], s24 offen offset:2304 nt
    v_mov_b32 v36, v40
    v_mov_b32 v37, v41
    v_mov_b32 v38, v42
    v_mov_b32 v39, v43
    v_mfma_f32_16x16x32_bf16 v[88:91], v[132:135], v[4:7], 0
    s_waitcnt vmcnt(5)
    s_bitcmp1_b32 s34, 20
    s_cbranch_scc1 L_w50
    s_waitcnt vmcnt(4)
L_w50:
    buffer_load_dwordx4 v[176:179], v1, s[16:19], s24 offen offset:2432 nt
    s_add_u32 s24, s24, 65536
    v_mov_b32 v40, v44
    v_mov_b32 v41, v45
    v_mov_b32 v42, v46
    v_mov_b32 v43, v47
    v_mfma_f32_16x16x32_bf16 v[88:91], v[136:139], v[8:11], v[88:91]
    s_waitcnt vmcnt(5)
    s_bitcmp1_b32 s34, 12
    s_cbranch_scc1 L_w51
    s_waitcnt vmcnt(4)
L_w51:
    buffer_load_dwordx4 v[180:183], v1, s[16:19], s24 offen offset:0 nt
    v_mov_b32 v44, v48
    v_mov_b32 v45, v49
    v_mov_b32 v46, v50
    v_mov_b32 v47, v51
    v_mfma_f32_16x16x32_bf16 v[88:91], v[140:143], v[12:15], v[88:91]
    s_waitcnt vmcnt(5)
    s_bitcmp1_b32 s34, 28
    s_cbranch_scc1 L_w52
    s_waitcnt vmcnt(4)
L_w52:
    buffer_load_dwordx4 v[184:187], v1, s[16:19], s24 offen offset:128 nt
    v_mfma_f32_16x16x32_bf16 v[88:91], v[144:147], v[16:19], v[88:91]
    v_add_f32_dpp v48, v85, v84 row_ror:4 row_mask:0xf bank_mask:0x1
    v_add_f32_dpp v49, v87, v86 row_ror:4 row_mask:0xf bank_mask:0x1
    s_nop 5
    v_add_f32_dpp v50, v89, v88 row_ror:4 row_mask:0xf bank_mask:0x1
    v_add_f32_dpp v51, v91, v90 row_ror:4 row_mask:0xf bank_mask:0x1
    s_waitcnt vmcnt(5)
    s_bitcmp1_b32 s34, 2
    s_cbranch_scc1 L_w53
    s_waitcnt vmcnt(4)
L_w53:
    buffer_load_dwordx4 v[188:191], v1, s[16:19], s24 offen offset:256 nt
    s_bitcmp1_b32 s36, s35
    s_cbranch_scc0 L_r54
    s_waitcnt lgkmcnt(0)
    s_sub_u32 s3, s40, s44
    s_mov_b32 s44, s45
    s_mov_b32 s45, s46
    s_mov_b32 s46, s47
    s_mov_b32 s47, s48
    s_max_i32 s3, s3, 0
    s_min_u32 s3, s3, 7
    s_lshl_b32 s3, s3, 3
    s_mov_b32 s32, 0x4020000
    s_mov_b32 s33, 0x20160e08
    s_lshr_b64 s[32:33], s[32:33], s3
    s_and_b32 s3, s32, 63
    s_bfm_b64 s[32:33], s3, 0
    v_mov_b32 v102, s32
    ds_write_b32 v114, v102
L_r54:
    v_mfma_f32_16x16x32_bf16 v[84:87], v[148:151], v[4:7], 0
    s_waitcnt vmcnt(5)
    s_bitcmp1_b32 s34, 18
    s_cbranch_scc1 L_w55
    s_waitcnt vmcnt(4)
L_w55:
    buffer_load_dwordx4 v[192:195], v1, s[16:19], s24 offen offset:384 nt
    v_mfma_f32_16x16x32_bf16 v[84:87], v[152:155], v[8:11], v[84:87]
    s_waitcnt vmcnt(5)
    s_bitcmp1_b32 s34, 10
    s_cbranch_scc1 L_w56
    s_waitcnt vmcnt(4)
L_w56:
    buffer_load_dwordx4 v[196:199], v1, s[16:19], s24 offen offset:2048 nt
    v_mfma_f32_16x16x32_bf16 v[84:87], v[156:159], v[12:15], v[84:87]
    s_waitcnt vmcnt(5)
    s_bitcmp1_b32 s34, 26
    s_cbranch_scc1 L_w57
    s_waitcnt vmcnt(4)
L_w57:
    buffer_load_dwordx4 v[200:203], v1, s[16:19], s24 offen offset:2176 nt
    v_mfma_f32_16x16x32_bf16 v[84:87], v[160:163], v[16:19], v[84:87]
    s_waitcnt vmcnt(5)
    s_bitcmp1_b32 s34, 6
    s_cbranch_scc1 L_w58
    s_waitcnt vmcnt(4)
L_w58:
    buffer_load_dwordx4 v[204:207], v1, s[16:19], s24 offen offset:2304 nt
    ds_read_b32 v103, v114
    v_mfma_f32_16x16x32_bf16 v[88:91], v[164:167], v[4:7], 0
    s_waitcnt vmcnt(5)
    s_bitcmp1_b32 s34, 22
    s_cbranch_scc1 L_w59
    s_waitcnt vmcnt(4)
L_w59:
    buffer_load_dwordx4 v[208:211], v1, s[16:19], s24 offen offset:2432 nt
    s_add_u32 s24, s24, 65536
    v_mfma_f32_16x16x32_bf16 v[88:91], v[168:171], v[8:11], v[88:91]
    s_waitcnt vmcnt(5)
    s_bitcmp1_b32 s34, 14
    s_cbranch_scc1 L_w60
    s_waitcnt vmcnt(4)
L_w60:
    buffer_load_dwordx4 v[212:215], v1, s[16:19], s24 offen offset:0 nt
    s_waitcnt lgkmcnt(0)
    v_readfirstlane_b32 s34, v103
    v_mfma_f32_16x16x32_bf16 v[88:91], v[172:175], v[12:15], v[88:91]
    s_waitcnt vmcnt(5)
    s_bitcmp1_b32 s34, 30
    s_cbranch_scc1 L_w61
    s_waitcnt vmcnt(4)
L_w61:
    buffer_load_dwordx4 v[216:219], v1, s[16:19], s24 offen offset:128 nt
    v_mfma_f32_16x16x32_bf16 v[88:91], v[176:179], v[16:19], v[88:91]
    v_add_f32_dpp v48, v84, v85 row_ror:4 row_mask:0xf bank_mask:0x2
    v_add_f32_dpp v49, v86, v87 row_ror:4 row_mask:0xf bank_mask:0x2
    s_nop 5
    v_add_f32_dpp v50, v88, v89 row_ror:4 row_mask:0xf bank_mask:0x2
    v_add_f32_dpp v51, v90, v91 row_ror:4 row_mask:0xf bank_mask:0x2
    s_waitcnt vmcnt(5)
    s_bitcmp1_b32 s34, 1
    s_cbranch_scc1 L_w62
    s_waitcnt vmcnt(4)
L_w62:
    buffer_load_dwordx4 v[220:223], v1, s[16:19], s24 offen offset:256 nt
    v_mfma_f32_16x16x32_bf16 v[84:87], v[180:183], v[4:7], 0
    s_waitcnt vmcnt(5)
    s_bitcmp1_b32 s34, 17
    s_cbranch_scc1 L_w63
    s_waitcnt vmcnt(4)
L_w63:
    buffer_load_dwordx4 v[224:227], v1, s[16:19], s24 offen offset:384 nt
    v_mfma_f32_16x16x32_bf16 v[84:87], v[184:187], v[8:11], v[84:87]
    s_waitcnt vmcnt(5)
    s_bitcmp1_b32 s34, 9
    s_cbranch_scc1 L_w64
    s_waitcnt vmcnt(4)
L_w64:
    buffer_load_dwordx4 v[228:231], v1, s[16:19], s24 offen offset:2048 nt
    v_mfma_f32_16x16x32_bf16 v[84:87], v[188:191], v[12:15], v[84:87]
    s_waitcnt vmcnt(5)
    s_bitcmp1_b32 s34, 25
    s_cbranch_scc1 L_w65
    s_waitcnt vmcnt(4)
L_w65:
    buffer_load_dwordx4 v[232:235], v1, s[16:19], s24 offen offset:2176 nt
    v_mfma_f32_16x16x32_bf16 v[84:87], v[192:195], v[16:19], v[84:87]
    s_waitcnt vmcnt(5)
    s_bitcmp1_b32 s34, 5
    s_cbranch_scc1 L_w66
    s_waitcnt vmcnt(4)
L_w66:
    buffer_load_dwordx4 v[236:239], v1, s[16:19], s24 offen offset:2304 nt
    ds_read_b32 v103, v114
    v_mfma_f32_16x16x32_bf16 v[88:91], v[196:199], v[4:7], 0
    s_waitcnt vmcnt(5)
    s_bitcmp1_b32 s34, 21
    s_cbranch_scc1 L_w67
    s_waitcnt vmcnt(4)
L_w67:
    buffer_load_dwordx4 v[240:243], v1, s[16:19], s24 offen offset:2432 nt
    s_add_u32 s24, s24, 65536
    v_mfma_f32_16x16x32_bf16 v[88:91], v[200:203], v[8:11], v[88:91]
    s_waitcnt vmcnt(5)
    s_bitcmp1_b32 s34, 13
    s_cbranch_scc1 L_w68
    s_waitcnt vmcnt(4)
L_w68:
    buffer_load_dwordx4 v[116:119], v2, s[20:23], s25 offen offset:0 nt
    s_waitcnt lgkmcnt(0)
    v_readfirstlane_b32 s34, v103
    v_mfma_f32_16x16x32_bf16 v[88:91], v[204:207], v[12:15], v[88:91]
    s_waitcnt vmcnt(5)
    s_bitcmp1_b32 s34, 29
    s_cbranch_scc1 L_w69
    s_waitcnt vmcnt(4)
L_w69:
    buffer_load_dwordx4 v[120:123], v3, s[20:23], s25 offen offset:0 nt
    v_mfma_f32_16x16x32_bf16 v[88:91], v[208:211], v[16:19], v[88:91]
    v_add_f32_dpp v48, v85, v84 row_ror:4 row_mask:0xf bank_mask:0x4
    v_add_f32_dpp v49, v87, v86 row_ror:4 row_mask:0xf bank_mask:0x4
    s_nop 5
    v_add_f32_dpp v50, v89, v88 row_ror:4 row_mask:0xf bank_mask:0x4
    v_add_f32_dpp v51, v91, v90 row_ror:4 row_mask:0xf bank_mask:0x4
    s_waitcnt vmcnt(5)
    s_bitcmp1_b32 s34, 3
    s_cbranch_scc1 L_w70
    s_waitcnt vmcnt(4)
L_w70:
    buffer_load_dwordx4 v[124:127], v2, s[20:23], s25 offen offset:2048 nt
    v_mfma_f32_16x16x32_bf16 v[84:87], v[212:215], v[4:7], 0
    s_waitcnt vmcnt(5)
    s_bitcmp1_b32 s34, 19
    s_cbranch_scc1 L_w71
    s_waitcnt vmcnt(4)
L_w71:
    buffer_load_dwordx4 v[128:131], v3, s[20:23], s25 offen offset:2048 nt
    v_mfma_f32_16x16x32_bf16 v[84:87], v[216:219], v[8:11], v[84:87]
    s_waitcnt vmcnt(5)
    s_bitcmp1_b32 s34, 11
    s_cbranch_scc1 L_w72
    s_waitcnt vmcnt(4)
L_w72:
    buffer_load_dwordx4 v[132:135], v2, s[20:23], s25 offen offset:1024 nt
    v_mfma_f32_16x16x32_bf16 v[84:87], v[220:223], v[12:15], v[84:87]
    s_waitcnt vmcnt(5)
    s_bitcmp1_b32 s34, 27
    s_cbranch_scc1 L_w73
    s_waitcnt vmcnt(4)
L_w73:
    buffer_load_dwordx4 v[136:139], v3, s[20:23], s25 offen offset:1024 nt
    v_mfma_f32_16x16x32_bf16 v[84:87], v[224:227], v[16:19], v[84:87]
    s_waitcnt vmcnt(5)
    s_bitcmp1_b32 s34, 7
    s_cbranch_scc1 L_w74
    s_waitcnt vmcnt(4)
L_w74:
    buffer_load_dwordx4 v[140:143], v2, s[20:23], s25 offen offset:3072 nt
    v_mfma_f32_16x16x32_bf16 v[88:91], v[228:231], v[4:7], 0
    s_waitcnt vmcnt(5)
    s_bitcmp1_b32 s34, 23
    s_cbranch_scc1 L_w75
    s_waitcnt vmcnt(4)
L_w75:
    buffer_load_dwordx4 v[144:147], v3, s[20:23], s25 offen offset:3072 nt
    s_add_u32 s25, s25, 65536
    v_mfma_f32_16x16x32_bf16 v[88:91], v[232:235], v[8:11], v[88:91]
    s_waitcnt vmcnt(5)
    s_bitcmp1_b32 s34, 15
    s_cbranch_scc1 L_w76
    s_waitcnt vmcnt(4)
L_w76:
    buffer_load_dwordx4 v[148:151], v2, s[20:23], s25 offen offset:0 nt
    v_mfma_f32_16x16x32_bf16 v[88:91], v[236:239], v[12:15], v[88:91]
    s_waitcnt vmcnt(5)
    s_bitcmp1_b32 s34, 31
    s_cbranch_scc1 L_w77
    s_waitcnt vmcnt(4)
L_w77:
    buffer_load_dwordx4 v[152:155], v3, s[20:23], s25 offen offset:0 nt
    s_add_u32 s35, s35, 1
    v_mfma_f32_16x16x32_bf16 v[88:91], v[240:243], v[16:19], v[88:91]
    v_add_f32_dpp v48, v84, v85 row_ror:4 row_mask:0xf bank_mask:0x8
    v_add_f32_dpp v49, v86, v87 row_ror:4 row_mask:0xf bank_mask:0x8
    s_nop 5
    v_add_f32_dpp v50, v88, v89 row_ror:4 row_mask:0xf bank_mask:0x8
    v_add_f32_dpp v51, v90, v91 row_ror:4 row_mask:0xf bank_mask:0x8
    v_max3_f32 v102, v20, v21, v22
    v_max3_f32 v103, v23, v24, v25
    v_max3_f32 v102, v102, v26, v27
    v_max3_f32 v103, v103, v28, v29
    v_max3_f32 v102, v102, v30, v31
    v_max3_f32 v103, v103, v32, v33
    v_max3_f32 v102, v102, v34, v35
    v_max3_f32 v103, v103, v36, v37
    v_max3_f32 v102, v102, v38, v39
    v_max3_f32 v103, v103, v40, v41
    v_max3_f32 v102, v102, v42, v43
    v_max3_f32 v103, v103, v44, v45
    v_max3_f32 v102, v102, v46, v47
    v_max3_f32 v103, v103, v48, v49
    v_max3_f32 v102, v102, v50, v51
    v_max_f32 v102, v102, v103
    s_nop 1
    v_max_f32_dpp v102, v102, v102 row_ror:4 row_mask:0xf bank_mask:0xf
    s_nop 1
    v_max_f32_dpp v102, v102, v102 row_ror:8 row_mask:0xf bank_mask:0xf
    v_mov_b32 v103, v102
    s_nop 1
    v_permlane16_swap_b32 v102, v103
    v_max_f32 v102, v102, v103
    v_mov_b32 v103, v102
    s_nop 1
    v_permlane32_swap_b32 v102, v103
    v_max_f32 v102, v102, v103
    v_mov_b32 v100, v102
    v_sub_f32 v20, v20, v100
    v_sub_f32 v21, v21, v100
    v_sub_f32 v22, v22, v100
    v_sub_f32 v23, v23, v100
    v_mul_f32 v20, s27, v20
    v_mul_f32 v21, s27, v21
    v_mul_f32 v22, s27, v22
    v_mul_f32 v23, s27, v23
    v_exp_f32 v20, v20
    v_exp_f32 v21, v21
    v_exp_f32 v22, v22
    v_exp_f32 v23, v23
    v_add_f32 v101, v20, v21
    v_add_f32 v102, v22, v23
    v_cvt_pk_bf16_f32 v20, v20, v21
    v_cvt_pk_bf16_f32 v21, v22, v23
    v_sub_f32 v24, v24, v100
    v_sub_f32 v25, v25, v100
    v_sub_f32 v26, v26, v100
    v_sub_f32 v27, v27, v100
    v_mul_f32 v24, s27, v24
    s_waitcnt vmcnt(5)
    s_bitcmp1_b32 s34, 10
    s_cbranch_scc1 L_w78
    s_waitcnt vmcnt(4)
L_w78:
    buffer_load_dwordx4 v[156:159], v2, s[20:23], s25 offen offset:2048 nt
    v_mul_f32 v25, s27, v25
    v_mul_f32 v26, s27, v26
    v_mul_f32 v27, s27, v27
    v_exp_f32 v24, v24
    v_exp_f32 v25, v25
    v_exp_f32 v26, v26
    v_exp_f32 v27, v27
    v_add_f32 v101, v101, v24
    v_add_f32 v102, v102, v25
    v_add_f32 v101, v101, v26
    v_add_f32 v102, v102, v27
    v_cvt_pk_bf16_f32 v22, v24, v25
    v_cvt_pk_bf16_f32 v23, v26, v27
    v_sub_f32 v28, v28, v100
    v_sub_f32 v29, v29, v100
    v_sub_f32 v30, v30, v100
    v_sub_f32 v31, v31, v100
    v_mul_f32 v28, s27, v28
    v_mul_f32 v29, s27, v29
    v_mul_f32 v30, s27, v30
    v_mul_f32 v31, s27, v31
    v_exp_f32 v28, v28
    v_exp_f32 v29, v29
    v_exp_f32 v30, v30
    v_exp_f32 v31, v31
    v_add_f32 v101, v101, v28
    v_add_f32 v102, v102, v29
    v_add_f32 v101, v101, v30
    v_add_f32 v102, v102, v31
    v_cvt_pk_bf16_f32 v24, v28, v29
    v_cvt_pk_bf16_f32 v25, v30, v31
    v_sub_f32 v32, v32, v100
    v_sub_f32 v33, v33, v100
    v_sub_f32 v34, v34, v100
    v_sub_f32 v35, v35, v100
    v_mul_f32 v32, s27, v32
    v_mul_f32 v33, s27, v33
    v_mul_f32 v34, s27, v34
    v_mul_f32 v35, s27, v35
    v_exp_f32 v32, v32
    v_exp_f32 v33, v33
    v_exp_f32 v34, v34
    v_exp_f32 v35, v35
    v_add_f32 v101, v101, v32
    v_add_f32 v102, v102, v33
    v_add_f32 v101, v101, v34
    s_waitcnt vmcnt(5)
    s_bitcmp1_b32 s34, 26
    s_cbranch_scc1 L_w79
    s_waitcnt vmcnt(4)
L_w79:
    buffer_load_dwordx4 v[160:163], v3, s[20:23], s25 offen offset:2048 nt
    v_add_f32 v102, v102, v35
    v_cvt_pk_bf16_f32 v26, v32, v33
    v_cvt_pk_bf16_f32 v27, v34, v35
    v_sub_f32 v36, v36, v100
    v_sub_f32 v37, v37, v100
    v_sub_f32 v38, v38, v100
    v_sub_f32 v39, v39, v100
    v_mul_f32 v36, s27, v36
    v_mul_f32 v37, s27, v37
    v_mul_f32 v38, s27, v38
    v_mul_f32 v39, s27, v39
    v_exp_f32 v36, v36
    v_exp_f32 v37, v37
    v_exp_f32 v38, v38
    v_exp_f32 v39, v39
    v_add_f32 v101, v101, v36
    v_add_f32 v102, v102, v37
    v_add_f32 v101, v101, v38
    v_add_f32 v102, v102, v39
    v_cvt_pk_bf16_f32 v28, v36, v37
    v_cvt_pk_bf16_f32 v29, v38, v39
    v_sub_f32 v40, v40, v100
    v_sub_f32 v41, v41, v100
    v_sub_f32 v42, v42, v100
    v_sub_f32 v43, v43, v100
    v_mul_f32 v40, s27, v40
    v_mul_f32 v41, s27, v41
    v_mul_f32 v42, s27, v42
    v_mul_f32 v43, s27, v43
    v_exp_f32 v40, v40
    v_exp_f32 v41, v41
    v_exp_f32 v42, v42
    v_exp_f32 v43, v43
    v_add_f32 v101, v101, v40
    v_add_f32 v102, v102, v41
    v_add_f32 v101, v101, v42
    v_add_f32 v102, v102, v43
    v_cvt_pk_bf16_f32 v30, v40, v41
    v_cvt_pk_bf16_f32 v31, v42, v43
    v_sub_f32 v44, v44, v100
    v_sub_f32 v45, v45, v100
    v_sub_f32 v46, v46, v100
    v_sub_f32 v47, v47, v100
    v_mul_f32 v44, s27, v44
    v_mul_f32 v45, s27, v45
    v_mul_f32 v46, s27, v46
    s_waitcnt vmcnt(5)
    s_bitcmp1_b32 s34, 6
    s_cbranch_scc1 L_w80
    s_waitcnt vmcnt(4)
L_w80:
    buffer_load_dwordx4 v[164:167], v2, s[20:23], s25 offen offset:1024 nt
    v_mul_f32 v47, s27, v47
    v_exp_f32 v44, v44
    v_exp_f32 v45, v45
    v_exp_f32 v46, v46
    v_exp_f32 v47, v47
    v_add_f32 v101, v101, v44
    v_add_f32 v102, v102, v45
    v_add_f32 v101, v101, v46
    v_add_f32 v102, v102, v47
    v_cvt_pk_bf16_f32 v32, v44, v45
    v_cvt_pk_bf16_f32 v33, v46, v47
    v_sub_f32 v48, v48, v100
    v_sub_f32 v49, v49, v100
    v_sub_f32 v50, v50, v100
    v_sub_f32 v51, v51, v100
    v_mul_f32 v48, s27, v48
    v_mul_f32 v49, s27, v49
    v_mul_f32 v50, s27, v50
    v_mul_f32 v51, s27, v51
    v_exp_f32 v48, v48
    v_exp_f32 v49, v49
    v_exp_f32 v50, v50
    v_exp_f32 v51, v51
    v_add_f32 v101, v101, v48
    v_add_f32 v102, v102, v49
    v_add_f32 v101, v101, v50
    v_add_f32 v102, v102, v51
    v_cvt_pk_bf16_f32 v34, v48, v49
    v_cvt_pk_bf16_f32 v35, v50, v51
    v_add_f32 v101, v101, v102
    s_nop 1
    v_add_f32_dpp v101, v101, v101 row_ror:4 row_mask:0xf bank_mask:0xf
    s_nop 1
    v_add_f32_dpp v101, v101, v101 row_ror:8 row_mask:0xf bank_mask:0xf
    v_mov_b32 v103, v101
    s_nop 1
    v_permlane16_swap_b32 v101, v103
    v_add_f32 v101, v101, v103
    v_mov_b32 v103, v101
    s_nop 1
    v_permlane32_swap_b32 v101, v103
    v_add_f32 v101, v101, v103
    s_lshl_b32 s3, s30, 3
    s_add_u32 s3, s3, 16384
    v_lshl_add_u32 v103, v104, 5, s3
    s_mov_b64 exec, 15
    ds_write_b64 v103, v[100:101]
    s_mov_b64 exec, -1
    v_and_b32 v102, 31, v104
    v_lshlrev_b32 v102, 5, v102
    v_lshrrev_b32 v103, 5, v104
    v_lshl_add_u32 v102, v103, 4, v102
    s_lshl_b32 s3, s30, 12
    v_add_u32 v111, s3, v102
    s_lshl_b32 s3, s30, 10
    v_add_u32 v105, s3, v2
    s_mov_b32 s26, 7
L_v:
    s_waitcnt vmcnt(5)
    s_bitcmp1_b32 s34, 0
    s_cbranch_scc1 L_w81
    s_waitcnt vmcnt(4)
L_w81:
    buffer_load_dwordx4 v[168:171], v3, s[20:23], s25 offen offset:1024 nt
    s_bitcmp1_b32 s36, s35
    s_cbranch_scc0 L_r82
    s_mul_i32 s3, s38, 8320
    s_add_u32 s3, s3, s37
    s_mov_b32 s40, 1
    s_atomic_add s40, s[14:15], s3 glc
    s_add_u32 s37, s37, 266240
    s_add_u32 s38, s38, s39
    s_and_b32 s38, s38, 31
L_r82:
    s_waitcnt vmcnt(5)
    s_bitcmp1_b32 s34, 16
    s_cbranch_scc1 L_w83
    s_waitcnt vmcnt(4)
L_w83:
    buffer_load_dwordx4 v[172:175], v2, s[20:23], s25 offen offset:3072 nt
    s_waitcnt vmcnt(5)
    s_bitcmp1_b32 s34, 8
    s_cbranch_scc1 L_w84
    s_waitcnt vmcnt(4)
L_w84:
    buffer_load_dwordx4 v[176:179], v3, s[20:23], s25 offen offset:3072 nt
    s_add_u32 s25, s25, 65536
    s_waitcnt vmcnt(5)
    s_bitcmp1_b32 s34, 24
    s_cbranch_scc1 L_w85
    s_waitcnt vmcnt(4)
L_w85:
    buffer_load_dwordx4 v[180:183], v2, s[20:23], s25 offen offset:0 nt
    v_perm_b32 v92, v120, v116, s28
    v_perm_b32 v93, v128, v124, s28
    v_perm_b32 v94, v120, v116, s29
    v_perm_b32 v95, v128, v124, s29
    v_mfma_f32_4x4x4_16b_bf16 v[52:55], v[20:21], v[92:93], v[52:55] cbsz:3 abid:0
    v_perm_b32 v96, v121, v117, s28
    v_perm_b32 v97, v129, v125, s28
    v_mfma_f32_4x4x4_16b_bf16 v[56:59], v[20:21], v[94:95], v[56:59] cbsz:3 abid:0
    v_perm_b32 v98, v121, v117, s29
    v_perm_b32 v99, v129, v125, s29
    v_mfma_f32_4x4x4_16b_bf16 v[60:63], v[20:21], v[96:97], v[60:63] cbsz:3 abid:0
    s_nop 0
    v_mfma_f32_4x4x4_16b_bf16 v[64:67], v[20:21], v[98:99], v[64:67] cbsz:3 abid:0
    s_waitcnt vmcnt(5)
    s_bitcmp1_b32 s34, 4
    s_cbranch_scc1 L_w86
    s_waitcnt vmcnt(4)
L_w86:
    buffer_load_dwordx4 v[184:187], v3, s[20:23], s25 offen offset:0 nt
    v_perm_b32 v92, v122, v118, s28
    v_perm_b32 v93, v130, v126, s28
    v_perm_b32 v94, v122, v118, s29
    v_perm_b32 v95, v130, v126, s29
    v_mfma_f32_4x4x4_16b_bf16 v[68:71], v[20:21], v[92:93], v[68:71] cbsz:3 abid:0
    v_perm_b32 v96, v123, v119, s28
    v_perm_b32 v97, v131, v127, s28
    v_mfma_f32_4x4x4_16b_bf16 v[72:75], v[20:21], v[94:95], v[72:75] cbsz:3 abid:0
    v_perm_b32 v98, v123, v119, s29
    v_perm_b32 v99, v131, v127, s29
    v_mfma_f32_4x4x4_16b_bf16 v[76:79], v[20:21], v[96:97], v[76:79] cbsz:3 abid:0
    s_nop 0
    v_mfma_f32_4x4x4_16b_bf16 v[80:83], v[20:21], v[98:99], v[80:83] cbsz:3 abid:0
    s_waitcnt vmcnt(5)
    s_bitcmp1_b32 s34, 20
    s_cbranch_scc1 L_w87
    s_waitcnt vmcnt(4)
L_w87:
    buffer_load_dwordx4 v[188:191], v2, s[20:23], s25 offen offset:2048 nt
    s_waitcnt vmcnt(5)
    s_bitcmp1_b32 s34, 12
    s_cbranch_scc1 L_w88
    s_waitcnt vmcnt(4)
L_w88:
    buffer_load_dwordx4 v[192:195], v3, s[20:23], s25 offen offset:2048 nt
    s_waitcnt vmcnt(5)
    s_bitcmp1_b32 s34, 28
    s_cbranch_scc1 L_w89
    s_waitcnt vmcnt(4)
L_w89:
    buffer_load_dwordx4 v[196:199], v2, s[20:23], s25 offen offset:1024 nt
    v_perm_b32 v92, v136, v132, s28
    v_perm_b32 v93, v144, v140, s28
    v_perm_b32 v94, v136, v132, s29
    v_perm_b32 v95, v144, v140, s29
    v_mfma_f32_4x4x4_16b_bf16 v[52:55], v[20:21], v[92:93], v[52:55] cbsz:3 abid:4
    v_perm_b32 v96, v137, v133, s28
    v_perm_b32 v97, v145, v141, s28
    v_mfma_f32_4x4x4_16b_bf16 v[56:59], v[20:21], v[94:95], v[56:59] cbsz:3 abid:4
    v_perm_b32 v98, v137, v133, s29
    v_perm_b32 v99, v145, v141, s29
    v_mfma_f32_4x4x4_16b_bf16 v[60:63], v[20:21], v[96:97], v[60:63] cbsz:3 abid:4
    v_perm_b32 v92, v138, v134, s28
    v_perm_b32 v93, v146, v142, s28
    v_mfma_f32_4x4x4_16b_bf16 v[64:67], v[20:21], v[98:99], v[64:67] cbsz:3 abid:4
    v_perm_b32 v94, v138, v134, s29
    v_perm_b32 v95, v146, v142, s29
    v_mfma_f32_4x4x4_16b_bf16 v[68:71], v[20:21], v[92:93], v[68:71] cbsz:3 abid:4
    v_perm_b32 v96, v139, v135, s28
    v_perm_b32 v97, v147, v143, s28
    v_mfma_f32_4x4x4_16b_bf16 v[72:75], v[20:21], v[94:95], v[72:75] cbsz:3 abid:4
    v_perm_b32 v98, v139, v135, s29
    v_perm_b32 v99, v147, v143, s29
    v_mfma_f32_4x4x4_16b_bf16 v[76:79], v[20:21], v[96:97], v[76:79] cbsz:3 abid:4
    s_nop 0
    v_mfma_f32_4x4x4_16b_bf16 v[80:83], v[20:21], v[98:99], v[80:83] cbsz:3 abid:4
    s_waitcnt vmcnt(5)
    s_bitcmp1_b32 s34, 2
    s_cbranch_scc1 L_w90
    s_waitcnt vmcnt(4)
L_w90:
    buffer_load_dwordx4 v[200:203], v3, s[20:23], s25 offen offset:1024 nt
    s_bitcmp1_b32 s36, s35
    s_cbranch_scc0 L_r91
    s_waitcnt lgkmcnt(0)
    s_sub_u32 s3, s40, s44
    s_mov_b32 s44, s45
    s_mov_b32 s45, s46
    s_mov_b32 s46, s47
    s_mov_b32 s47, s48
    s_max_i32 s3, s3, 0
    s_min_u32 s3, s3, 7
    s_lshl_b32 s3, s3, 3
    s_mov_b32 s32, 0x4020000
    s_mov_b32 s33, 0x20160e08
    s_lshr_b64 s[32:33], s[32:33], s3
    s_and_b32 s3, s32, 63
    s_bfm_b64 s[32:33], s3, 0
    v_mov_b32 v102, s32
    ds_write_b32 v114, v102
L_r91:
    s_waitcnt vmcnt(5)
    s_bitcmp1_b32 s34, 18
    s_cbranch_scc1 L_w92
    s_waitcnt vmcnt(4)
L_w92:
    buffer_load_dwordx4 v[204:207], v2, s[20:23], s25 offen offset:3072 nt
    s_waitcnt vmcnt(5)
    s_bitcmp1_b32 s34, 10
    s_cbranch_scc1 L_w93
    s_waitcnt vmcnt(4)
L_w93:
    buffer_load_dwordx4 v[208:211], v3, s[20:23], s25 offen offset:3072 nt
    s_add_u32 s25, s25, 65536
    s_waitcnt vmcnt(5)
    s_bitcmp1_b32 s34, 26
    s_cbranch_scc1 L_w94
    s_waitcnt vmcnt(4)
L_w94:
    buffer_load_dwordx4 v[212:215], v2, s[20:23], s25 offen offset:0 nt
    v_perm_b32 v92, v152, v148, s28
    v_perm_b32 v93, v160, v156, s28
    v_perm_b32 v94, v152, v148, s29
    v_perm_b32 v95, v160, v156, s29
    v_mfma_f32_4x4x4_16b_bf16 v[52:55], v[20:21], v[92:93], v[52:55] cbsz:3 abid:1
    v_perm_b32 v96, v153, v149, s28
    v_perm_b32 v97, v161, v157, s28
    v_mfma_f32_4x4x4_16b_bf16 v[56:59], v[20:21], v[94:95], v[56:59] cbsz:3 abid:1
    v_perm_b32 v98, v153, v149, s29
    v_perm_b32 v99, v161, v157, s29
    v_mfma_f32_4x4x4_16b_bf16 v[60:63], v[20:21], v[96:97], v[60:63] cbsz:3 abid:1
    s_nop 0
    v_mfma_f32_4x4x4_16b_bf16 v[64:67], v[20:21], v[98:99], v[64:67] cbsz:3 abid:1
    s_waitcnt vmcnt(5)
    s_bitcmp1_b32 s34, 6
    s_cbranch_scc1 L_w95
    s_waitcnt vmcnt(4)
L_w95:
    buffer_load_dwordx4 v[216:219], v3, s[20:23], s25 offen offset:0 nt
    ds_read_b32 v103, v114
    v_perm_b32 v92, v154, v150, s28
    v_perm_b32 v93, v162, v158, s28
    v_perm_b32 v94, v154, v150, s29
    v_perm_b32 v95, v162, v158, s29
    v_mfma_f32_4x4x4_16b_bf16 v[68:71], v[20:21], v[92:93], v[68:71] cbsz:3 abid:1
    v_perm_b32 v96, v155, v151, s28
    v_perm_b32 v97, v163, v159, s28
    v_mfma_f32_4x4x4_16b_bf16 v[72:75], v[20:21], v[94:95], v[72:75] cbsz:3 abid:1
    v_perm_b32 v98, v155, v151, s29
    v_perm_b32 v99, v163, v159, s29
    v_mfma_f32_4x4x4_16b_bf16 v[76:79], v[20:21], v[96:97], v[76:79] cbsz:3 abid:1
    s_nop 0
    v_mfma_f32_4x4x4_16b_bf16 v[80:83], v[20:21], v[98:99], v[80:83] cbsz:3 abid:1
    s_waitcnt vmcnt(5)
    s_bitcmp1_b32 s34, 22
    s_cbranch_scc1 L_w96
    s_waitcnt vmcnt(4)
L_w96:
    buffer_load_dwordx4 v[220:223], v2, s[20:23], s25 offen offset:2048 nt
    s_waitcnt vmcnt(5)
    s_bitcmp1_b32 s34, 14
    s_cbranch_scc1 L_w97
    s_waitcnt vmcnt(4)
L_w97:
    buffer_load_dwordx4 v[224:227], v3, s[20:23], s25 offen offset:2048 nt
    s_waitcnt lgkmcnt(0)
    v_readfirstlane_b32 s34, v103
    s_waitcnt vmcnt(5)
    s_bitcmp1_b32 s34, 30
    s_cbranch_scc1 L_w98
    s_waitcnt vmcnt(4)
L_w98:
    buffer_load_dwordx4 v[228:231], v2, s[20:23], s25 offen offset:1024 nt
    v_perm_b32 v92, v168, v164, s28
    v_perm_b32 v93, v176, v172, s28
    v_perm_b32 v94, v168, v164, s29
    v_perm_b32 v95, v176, v172, s29
    v_mfma_f32_4x4x4_16b_bf16 v[52:55], v[20:21], v[92:93], v[52:55] cbsz:3 abid:5
    v_perm_b32 v96, v169, v165, s28
    v_perm_b32 v97, v177, v173, s28
    v_mfma_f32_4x4x4_16b_bf16 v[56:59], v[20:21], v[94:95], v[56:59] cbsz:3 abid:5
    v_perm_b32 v98, v169, v165, s29
    v_perm_b32 v99, v177, v173, s29
    v_mfma_f32_4x4x4_16b_bf16 v[60:63], v[20:21], v[96:97], v[60:63] cbsz:3 abid:5
    v_perm_b32 v92, v170, v166, s28
    v_perm_b32 v93, v178, v174, s28
    v_mfma_f32_4x4x4_16b_bf16 v[64:67], v[20:21], v[98:99], v[64:67] cbsz:3 abid:5
    v_perm_b32 v94, v170, v166, s29
    v_perm_b32 v95, v178, v174, s29
    v_mfma_f32_4x4x4_16b_bf16 v[68:71], v[20:21], v[92:93], v[68:71] cbsz:3 abid:5
    v_perm_b32 v96, v171, v167, s28
    v_perm_b32 v97, v179, v175, s28
    v_mfma_f32_4x4x4_16b_bf16 v[72:75], v[20:21], v[94:95], v[72:75] cbsz:3 abid:5
    v_perm_b32 v98, v171, v167, s29
    v_perm_b32 v99, v179, v175, s29
    v_mfma_f32_4x4x4_16b_bf16 v[76:79], v[20:21], v[96:97], v[76:79] cbsz:3 abid:5
    s_nop 0
    v_mfma_f32_4x4x4_16b_bf16 v[80:83], v[20:21], v[98:99], v[80:83] cbsz:3 abid:5
    s_waitcnt vmcnt(5)
    s_bitcmp1_b32 s34, 1
    s_cbranch_scc1 L_w99
    s_waitcnt vmcnt(4)
L_w99:
    buffer_load_dwordx4 v[232:235], v3, s[20:23], s25 offen offset:1024 nt
    s_waitcnt vmcnt(5)
    s_bitcmp1_b32 s34, 17
    s_cbranch_scc1 L_w100
    s_waitcnt vmcnt(4)
L_w100:
    buffer_load_dwordx4 v[236:239], v2, s[20:23], s25 offen offset:3072 nt
    s_waitcnt vmcnt(5)
    s_bitcmp1_b32 s34, 9
    s_cbranch_scc1 L_w101
    s_waitcnt vmcnt(4)
L_w101:
    buffer_load_dwordx4 v[240:243], v3, s[20:23], s25 offen offset:3072 nt
    s_add_u32 s25, s25, 65536
    s_waitcnt vmcnt(5)
    s_bitcmp1_b32 s34, 25
    s_cbranch_scc1 L_w102
    s_waitcnt vmcnt(4)
L_w102:
    buffer_load_dwordx4 v[116:119], v2, s[20:23], s25 offen offset:0 nt
    v_perm_b32 v92, v184, v180, s28
    v_perm_b32 v93, v192, v188, s28
    v_perm_b32 v94, v184, v180, s29
    v_perm_b32 v95, v192, v188, s29
    v_mfma_f32_4x4x4_16b_bf16 v[52:55], v[20:21], v[92:93], v[52:55] cbsz:3 abid:2
    v_perm_b32 v96, v185, v181, s28
    v_perm_b32 v97, v193, v189, s28
    v_mfma_f32_4x4x4_16b_bf16 v[56:59], v[20:21], v[94:95], v[56:59] cbsz:3 abid:2
    v_perm_b32 v98, v185, v181, s29
    v_perm_b32 v99, v193, v189, s29
    v_mfma_f32_4x4x4_16b_bf16 v[60:63], v[20:21], v[96:97], v[60:63] cbsz:3 abid:2
    s_nop 0
    v_mfma_f32_4x4x4_16b_bf16 v[64:67], v[20:21], v[98:99], v[64:67] cbsz:3 abid:2
    s_waitcnt vmcnt(5)
    s_bitcmp1_b32 s34, 5
    s_cbranch_scc1 L_w103
    s_waitcnt vmcnt(4)
L_w103:
    buffer_load_dwordx4 v[120:123], v3, s[20:23], s25 offen offset:0 nt
    ds_read_b32 v103, v114
    v_perm_b32 v92, v186, v182, s28
    v_perm_b32 v93, v194, v190, s28
    v_perm_b32 v94, v186, v182, s29
    v_perm_b32 v95, v194, v190, s29
    v_mfma_f32_4x4x4_16b_bf16 v[68:71], v[20:21], v[92:93], v[68:71] cbsz:3 abid:2
    v_perm_b32 v96, v187, v183, s28
    v_perm_b32 v97, v195, v191, s28
    v_mfma_f32_4x4x4_16b_bf16 v[72:75], v[20:21], v[94:95], v[72:75] cbsz:3 abid:2
    v_perm_b32 v98, v187, v183, s29
    v_perm_b32 v99, v195, v191, s29
    v_mfma_f32_4x4x4_16b_bf16 v[76:79], v[20:21], v[96:97], v[76:79] cbsz:3 abid:2
    s_nop 0
    v_mfma_f32_4x4x4_16b_bf16 v[80:83], v[20:21], v[98:99], v[80:83] cbsz:3 abid:2
    s_waitcnt vmcnt(5)
    s_bitcmp1_b32 s34, 21
    s_cbranch_scc1 L_w104
    s_waitcnt vmcnt(4)
L_w104:
    buffer_load_dwordx4 v[124:127], v2, s[20:23], s25 offen offset:2048 nt
    s_waitcnt vmcnt(5)
    s_bitcmp1_b32 s34, 13
    s_cbranch_scc1 L_w105
    s_waitcnt vmcnt(4)
L_w105:
    buffer_load_dwordx4 v[128:131], v3, s[20:23], s25 offen offset:2048 nt
    s_waitcnt lgkmcnt(0)
    v_readfirstlane_b32 s34, v103
    s_waitcnt vmcnt(5)
    s_bitcmp1_b32 s34, 29
    s_cbranch_scc1 L_w106
    s_waitcnt vmcnt(4)
L_w106:
    buffer_load_dwordx4 v[132:135], v2, s[20:23], s25 offen offset:1024 nt
    v_perm_b32 v92, v200, v196, s28
    v_perm_b32 v93, v208, v204, s28
    v_perm_b32 v94, v200, v196, s29
    v_perm_b32 v95, v208, v204, s29
    v_mfma_f32_4x4x4_16b_bf16 v[52:55], v[20:21], v[92:93], v[52:55] cbsz:3 abid:6
    v_perm_b32 v96, v201, v197, s28
    v_perm_b32 v97, v209, v205, s28
    v_mfma_f32_4x4x4_16b_bf16 v[56:59], v[20:21], v[94:95], v[56:59] cbsz:3 abid:6
    v_perm_b32 v98, v201, v197, s29
    v_perm_b32 v99, v209, v205, s29
    v_mfma_f32_4x4x4_16b_bf16 v[60:63], v[20:21], v[96:97], v[60:63] cbsz:3 abid:6
    v_perm_b32 v92, v202, v198, s28
    v_perm_b32 v93, v210, v206, s28
    v_mfma_f32_4x4x4_16b_bf16 v[64:67], v[20:21], v[98:99], v[64:67] cbsz:3 abid:6
    v_perm_b32 v94, v202, v198, s29
    v_perm_b32 v95, v210, v206, s29
    v_mfma_f32_4x4x4_16b_bf16 v[68:71], v[20:21], v[92:93], v[68:71] cbsz:3 abid:6
    v_perm_b32 v96, v203, v199, s28
    v_perm_b32 v97, v211, v207, s28
    v_mfma_f32_4x4x4_16b_bf16 v[72:75], v[20:21], v[94:95], v[72:75] cbsz:3 abid:6
    v_perm_b32 v98, v203, v199, s29
    v_perm_b32 v99, v211, v207, s29
    v_mfma_f32_4x4x4_16b_bf16 v[76:79], v[20:21], v[96:97], v[76:79] cbsz:3 abid:6
    s_nop 0
    v_mfma_f32_4x4x4_16b_bf16 v[80:83], v[20:21], v[98:99], v[80:83] cbsz:3 abid:6
    s_waitcnt vmcnt(5)
    s_bitcmp1_b32 s34, 3
    s_cbranch_scc1 L_w107
    s_waitcnt vmcnt(4)
L_w107:
    buffer_load_dwordx4 v[136:139], v3, s[20:23], s25 offen offset:1024 nt
    s_waitcnt vmcnt(5)
    s_bitcmp1_b32 s34, 19
    s_cbranch_scc1 L_w108
    s_waitcnt vmcnt(4)
L_w108:
    buffer_load_dwordx4 v[140:143], v2, s[20:23], s25 offen offset:3072 nt
    s_waitcnt vmcnt(5)
    s_bitcmp1_b32 s34, 11
    s_cbranch_scc1 L_w109
    s_waitcnt vmcnt(4)
L_w109:
    buffer_load_dwordx4 v[144:147], v3, s[20:23], s25 offen offset:3072 nt
    s_add_u32 s25, s25, 65536
    s_waitcnt vmcnt(5)
    s_bitcmp1_b32 s34, 27
    s_cbranch_scc1 L_w110
    s_waitcnt vmcnt(4)
L_w110:
    buffer_load_dwordx4 v[148:151], v2, s[20:23], s25 offen offset:0 nt
    v_perm_b32 v92, v216, v212, s28
    v_perm_b32 v93, v224, v220, s28
    v_perm_b32 v94, v216, v212, s29
    v_perm_b32 v95, v224, v220, s29
    v_mfma_f32_4x4x4_16b_bf16 v[52:55], v[20:21], v[92:93], v[52:55] cbsz:3 abid:3
    v_perm_b32 v96, v217, v213, s28
    v_perm_b32 v97, v225, v221, s28
    v_mfma_f32_4x4x4_16b_bf16 v[56:59], v[20:21], v[94:95], v[56:59] cbsz:3 abid:3
    v_perm_b32 v98, v217, v213, s29
    v_perm_b32 v99, v225, v221, s29
    v_mfma_f32_4x4x4_16b_bf16 v[60:63], v[20:21], v[96:97], v[60:63] cbsz:3 abid:3
    s_nop 0
    v_mfma_f32_4x4x4_16b_bf16 v[64:67], v[20:21], v[98:99], v[64:67] cbsz:3 abid:3
    s_waitcnt vmcnt(5)
    s_bitcmp1_b32 s34, 7
    s_cbranch_scc1 L_w111
    s_waitcnt vmcnt(4)
L_w111:
    buffer_load_dwordx4 v[152:155], v3, s[20:23], s25 offen offset:0 nt
    v_perm_b32 v92, v218, v214, s28
    v_perm_b32 v93, v226, v222, s28
    v_perm_b32 v94, v218, v214, s29
    v_perm_b32 v95, v226, v222, s29
    v_mfma_f32_4x4x4_16b_bf16 v[68:71], v[20:21], v[92:93], v[68:71] cbsz:3 abid:3
    v_perm_b32 v96, v219, v215, s28
    v_perm_b32 v97, v227, v223, s28
    v_mfma_f32_4x4x4_16b_bf16 v[72:75], v[20:21], v[94:95], v[72:75] cbsz:3 abid:3
    v_perm_b32 v98, v219, v215, s29
    v_perm_b32 v99, v227, v223, s29
    v_mfma_f32_4x4x4_16b_bf16 v[76:79], v[20:21], v[96:97], v[76:79] cbsz:3 abid:3
    s_nop 0
    v_mfma_f32_4x4x4_16b_bf16 v[80:83], v[20:21], v[98:99], v[80:83] cbsz:3 abid:3
    s_waitcnt vmcnt(5)
    s_bitcmp1_b32 s34, 23
    s_cbranch_scc1 L_w112
    s_waitcnt vmcnt(4)
L_w112:
    buffer_load_dwordx4 v[156:159], v2, s[20:23], s25 offen offset:2048 nt
    s_waitcnt vmcnt(5)
    s_bitcmp1_b32 s34, 15
    s_cbranch_scc1 L_w113
    s_waitcnt vmcnt(4)
L_w113:
    buffer_load_dwordx4 v[160:163], v3, s[20:23], s25 offen offset:2048 nt
    s_waitcnt vmcnt(5)
    s_bitcmp1_b32 s34, 31
    s_cbranch_scc1 L_w114
    s_waitcnt vmcnt(4)
L_w114:
    buffer_load_dwordx4 v[164:167], v2, s[20:23], s25 offen offset:1024 nt
    s_add_u32 s35, s35, 1
    v_perm_b32 v92, v232, v228, s28
    v_perm_b32 v93, v240, v236, s28
    v_perm_b32 v94, v232, v228, s29
    v_perm_b32 v95, v240, v236, s29
    v_mfma_f32_4x4x4_16b_bf16 v[52:55], v[20:21], v[92:93], v[52:55] cbsz:3 abid:7
    v_perm_b32 v96, v233, v229, s28
    v_perm_b32 v97, v241, v237, s28
    v_mfma_f32_4x4x4_16b_bf16 v[56:59], v[20:21], v[94:95], v[56:59] cbsz:3 abid:7
    v_perm_b32 v98, v233, v229, s29
    v_perm_b32 v99, v241, v237, s29
    v_mfma_f32_4x4x4_16b_bf16 v[60:63], v[20:21], v[96:97], v[60:63] cbsz:3 abid:7
    v_perm_b32 v92, v234, v230, s28
    v_perm_b32 v93, v242, v238, s28
    v_mfma_f32_4x4x4_16b_bf16 v[64:67], v[20:21], v[98:99], v[64:67] cbsz:3 abid:7
    v_perm_b32 v94, v234, v230, s29
    v_perm_b32 v95, v242, v238, s29
    v_mfma_f32_4x4x4_16b_bf16 v[68:71], v[20:21], v[92:93], v[68:71] cbsz:3 abid:7
    v_perm_b32 v96, v235, v231, s28
    v_perm_b32 v97, v243, v239, s28
    v_mfma_f32_4x4x4_16b_bf16 v[72:75], v[20:21], v[94:95], v[72:75] cbsz:3 abid:7
    v_perm_b32 v98, v235, v231, s29
    v_perm_b32 v99, v243, v239, s29
    v_mfma_f32_4x4x4_16b_bf16 v[76:79], v[20:21], v[96:97], v[76:79] cbsz:3 abid:7
    s_nop 0
    v_mfma_f32_4x4x4_16b_bf16 v[80:83], v[20:21], v[98:99], v[80:83] cbsz:3 abid:7
    v_mov_b32 v20, v22
    v_mov_b32 v21, v23
    v_mov_b32 v22, v24
    v_mov_b32 v23, v25
    v_mov_b32 v24, v26
    v_mov_b32 v25, v27
    v_mov_b32 v26, v28
    v_mov_b32 v27, v29
    v_mov_b32 v28, v30
    v_mov_b32 v29, v31
    v_mov_b32 v30, v32
    v_mov_b32 v31, v33
    v_mov_b32 v32, v34
    v_mov_b32 v33, v35
    s_sub_u32 s26, s26, 1
    s_cmp_lg_u32 s26, 0
    s_cbranch_scc1 L_v
    s_mov_b32 s44, 0x05030201
    s_mov_b32 s45, 0x06050302
    s_mov_b32 s46, 0x07060503
    s_mov_b32 s47, 0x0504030c
    s_mov_b32 s48, 0x0403020c
    s_mov_b32 s49, 0xffffff00
    s_waitcnt vmcnt(7)
    s_bitcmp1_b32 s34, 0
    s_cbranch_scc1 L_w115
    s_waitcnt vmcnt(4)
L_w115:
    buffer_load_dwordx4 v[168:171], v3, s[20:23], s25 offen offset:1024 nt
    s_waitcnt vmcnt(7)
    s_bitcmp1_b32 s34, 16
    s_cbranch_scc1 L_w116
    s_waitcnt vmcnt(4)
L_w116:
    buffer_load_dwordx4 v[172:175], v2, s[20:23], s25 offen offset:3072 nt
    s_waitcnt vmcnt(7)
    s_bitcmp1_b32 s34, 8
    s_cbranch_scc1 L_w117
    s_waitcnt vmcnt(4)
L_w117:
    buffer_load_dwordx4 v[176:179], v3, s[20:23], s25 offen offset:3072 nt
    s_add_u32 s25, s25, 65536
    s_waitcnt vmcnt(7)
    s_bitcmp1_b32 s34, 24
    s_cbranch_scc1 L_w118
    s_waitcnt vmcnt(4)
L_w118:
    buffer_load_dwordx4 v[180:183], v2, s[20:23], s25 offen offset:0 nt
    v_perm_b32 v92, v120, v116, s28
    v_perm_b32 v93, v128, v124, s28
    v_perm_b32 v94, v120, v116, s29
    v_perm_b32 v95, v128, v124, s29
    v_mfma_f32_4x4x4_16b_bf16 v[52:55], v[20:21], v[92:93], v[52:55] cbsz:3 abid:0
    v_perm_b32 v96, v121, v117, s28
    v_perm_b32 v97, v129, v125, s28
    v_mfma_f32_4x4x4_16b_bf16 v[56:59], v[20:21], v[94:95], v[56:59] cbsz:3 abid:0
    v_perm_b32 v98, v121, v117, s29
    v_perm_b32 v99, v129, v125, s29
    v_mfma_f32_4x4x4_16b_bf16 v[60:63], v[20:21], v[96:97], v[60:63] cbsz:3 abid:0
    s_nop 0
    v_mfma_f32_4x4x4_16b_bf16 v[64:67], v[20:21], v[98:99], v[64:67] cbsz:3 abid:0
    s_waitcnt vmcnt(7)
    s_bitcmp1_b32 s34, 4
    s_cbranch_scc1 L_w119
    s_waitcnt vmcnt(4)
L_w119:
    buffer_load_dwordx4 v[184:187], v3, s[20:23], s25 offen offset:0 nt
    v_perm_b32 v92, v122, v118, s28
    v_perm_b32 v93, v130, v126, s28
    v_perm_b32 v94, v122, v118, s29
    v_perm_b32 v95, v130, v126, s29
    v_mfma_f32_4x4x4_16b_bf16 v[68:71], v[20:21], v[92:93], v[68:71] cbsz:3 abid:0
    v_perm_b32 v96, v123, v119, s28
    v_perm_b32 v97, v131, v127, s28
    v_mfma_f32_4x4x4_16b_bf16 v[72:75], v[20:21], v[94:95], v[72:75] cbsz:3 abid:0
    v_perm_b32 v98, v123, v119, s29
    v_perm_b32 v99, v131, v127, s29
    v_mfma_f32_4x4x4_16b_bf16 v[76:79], v[20:21], v[96:97], v[76:79] cbsz:3 abid:0
    s_nop 0
    v_mfma_f32_4x4x4_16b_bf16 v[80:83], v[20:21], v[98:99], v[80:83] cbsz:3 abid:0
    s_waitcnt vmcnt(7)
    s_bitcmp1_b32 s34, 20
    s_cbranch_scc1 L_w120
    s_waitcnt vmcnt(4)
L_w120:
    buffer_load_dwordx4 v[188:191], v2, s[20:23], s25 offen offset:2048 nt
    s_waitcnt vmcnt(7)
    s_bitcmp1_b32 s34, 12
    s_cbranch_scc1 L_w121
    s_waitcnt vmcnt(4)
L_w121:
    buffer_load_dwordx4 v[192:195], v3, s[20:23], s25 offen offset:2048 nt
    s_waitcnt vmcnt(7)
    s_bitcmp1_b32 s34, 28
    s_cbranch_scc1 L_w122
    s_waitcnt vmcnt(4)
L_w122:
    buffer_load_dwordx4 v[196:199], v2, s[20:23], s25 offen offset:1024 nt
    v_perm_b32 v92, v136, v132, s28
    v_perm_b32 v93, v144, v140, s28
    v_perm_b32 v94, v136, v132, s29
    v_perm_b32 v95, v144, v140, s29
    v_mfma_f32_4x4x4_16b_bf16 v[52:55], v[20:21], v[92:93], v[52:55] cbsz:3 abid:4
    v_perm_b32 v96, v137, v133, s28
    v_perm_b32 v97, v145, v141, s28
    v_mfma_f32_4x4x4_16b_bf16 v[56:59], v[20:21], v[94:95], v[56:59] cbsz:3 abid:4
    v_perm_b32 v98, v137, v133, s29
    v_perm_b32 v99, v145, v141, s29
    v_mfma_f32_4x4x4_16b_bf16 v[60:63], v[20:21], v[96:97], v[60:63] cbsz:3 abid:4
    v_perm_b32 v92, v138, v134, s28
    v_perm_b32 v93, v146, v142, s28
    v_mfma_f32_4x4x4_16b_bf16 v[64:67], v[20:21], v[98:99], v[64:67] cbsz:3 abid:4
    v_perm_b32 v94, v138, v134, s29
    v_perm_b32 v95, v146, v142, s29
    v_mfma_f32_4x4x4_16b_bf16 v[68:71], v[20:21], v[92:93], v[68:71] cbsz:3 abid:4
    v_perm_b32 v96, v139, v135, s28
    v_perm_b32 v97, v147, v143, s28
    v_mfma_f32_4x4x4_16b_bf16 v[72:75], v[20:21], v[94:95], v[72:75] cbsz:3 abid:4
    v_perm_b32 v98, v139, v135, s29
    v_perm_b32 v99, v147, v143, s29
    v_mfma_f32_4x4x4_16b_bf16 v[76:79], v[20:21], v[96:97], v[76:79] cbsz:3 abid:4
    s_nop 0
    v_mfma_f32_4x4x4_16b_bf16 v[80:83], v[20:21], v[98:99], v[80:83] cbsz:3 abid:4
    s_waitcnt vmcnt(7)
    s_bitcmp1_b32 s34, 2
    s_cbranch_scc1 L_w123
    s_waitcnt vmcnt(4)
L_w123:
    buffer_load_dwordx4 v[200:203], v3, s[20:23], s25 offen offset:1024 nt
    s_waitcnt vmcnt(7)
    s_bitcmp1_b32 s34, 18
    s_cbranch_scc1 L_w124
    s_waitcnt vmcnt(4)
L_w124:
    buffer_load_dwordx4 v[204:207], v2, s[20:23], s25 offen offset:3072 nt
    s_waitcnt vmcnt(7)
    s_bitcmp1_b32 s34, 10
    s_cbranch_scc1 L_w125
    s_waitcnt vmcnt(4)
L_w125:
    buffer_load_dwordx4 v[208:211], v3, s[20:23], s25 offen offset:3072 nt
    s_add_u32 s25, s25, 65536
    s_waitcnt vmcnt(7)
    s_bitcmp1_b32 s34, 26
    s_cbranch_scc1 L_w126
    s_waitcnt vmcnt(4)
L_w126:
    buffer_load_dwordx4 v[212:215], v2, s[20:23], s25 offen offset:0 nt
    v_perm_b32 v92, v152, v148, s28
    v_perm_b32 v93, v160, v156, s28
    v_perm_b32 v94, v152, v148, s29
    v_perm_b32 v95, v160, v156, s29
    v_mfma_f32_4x4x4_16b_bf16 v[52:55], v[20:21], v[92:93], v[52:55] cbsz:3 abid:1
    v_perm_b32 v96, v153, v149, s28
    v_perm_b32 v97, v161, v157, s28
    v_mfma_f32_4x4x4_16b_bf16 v[56:59], v[20:21], v[94:95], v[56:59] cbsz:3 abid:1
    v_perm_b32 v98, v153, v149, s29
    v_perm_b32 v99, v161, v157, s29
    v_mfma_f32_4x4x4_16b_bf16 v[60:63], v[20:21], v[96:97], v[60:63] cbsz:3 abid:1
    s_nop 0
    v_mfma_f32_4x4x4_16b_bf16 v[64:67], v[20:21], v[98:99], v[64:67] cbsz:3 abid:1
    s_waitcnt vmcnt(7)
    s_bitcmp1_b32 s34, 6
    s_cbranch_scc1 L_w127
    s_waitcnt vmcnt(4)
L_w127:
    buffer_load_dwordx4 v[216:219], v3, s[20:23], s25 offen offset:0 nt
    v_perm_b32 v92, v154, v150, s28
    v_perm_b32 v93, v162, v158, s28
    v_perm_b32 v94, v154, v150, s29
    v_perm_b32 v95, v162, v158, s29
    v_mfma_f32_4x4x4_16b_bf16 v[68:71], v[20:21], v[92:93], v[68:71] cbsz:3 abid:1
    v_perm_b32 v96, v155, v151, s28
    v_perm_b32 v97, v163, v159, s28
    v_mfma_f32_4x4x4_16b_bf16 v[72:75], v[20:21], v[94:95], v[72:75] cbsz:3 abid:1
    v_perm_b32 v98, v155, v151, s29
    v_perm_b32 v99, v163, v159, s29
    v_mfma_f32_4x4x4_16b_bf16 v[76:79], v[20:21], v[96:97], v[76:79] cbsz:3 abid:1
    s_nop 0
    v_mfma_f32_4x4x4_16b_bf16 v[80:83], v[20:21], v[98:99], v[80:83] cbsz:3 abid:1
    s_waitcnt vmcnt(7)
    s_bitcmp1_b32 s34, 22
    s_cbranch_scc1 L_w128
    s_waitcnt vmcnt(4)
L_w128:
    buffer_load_dwordx4 v[220:223], v2, s[20:23], s25 offen offset:2048 nt
    s_waitcnt vmcnt(7)
    s_bitcmp1_b32 s34, 14
    s_cbranch_scc1 L_w129
    s_waitcnt vmcnt(4)
L_w129:
    buffer_load_dwordx4 v[224:227], v3, s[20:23], s25 offen offset:2048 nt
    s_waitcnt vmcnt(7)
    buffer_load_dwordx4 v[228:231], v2, s[20:23], s25 offen offset:1024 nt
    v_perm_b32 v92, v168, v164, s28
    v_perm_b32 v93, v176, v172, s28
    v_perm_b32 v94, v168, v164, s29
    v_perm_b32 v95, v176, v172, s29
    v_mfma_f32_4x4x4_16b_bf16 v[52:55], v[20:21], v[92:93], v[52:55] cbsz:3 abid:5
    v_perm_b32 v96, v169, v165, s28
    v_perm_b32 v97, v177, v173, s28
    v_mfma_f32_4x4x4_16b_bf16 v[56:59], v[20:21], v[94:95], v[56:59] cbsz:3 abid:5
    v_perm_b32 v98, v169, v165, s29
    v_perm_b32 v99, v177, v173, s29
    v_mfma_f32_4x4x4_16b_bf16 v[60:63], v[20:21], v[96:97], v[60:63] cbsz:3 abid:5
    v_perm_b32 v92, v170, v166, s28
    v_perm_b32 v93, v178, v174, s28
    v_mfma_f32_4x4x4_16b_bf16 v[64:67], v[20:21], v[98:99], v[64:67] cbsz:3 abid:5
    v_perm_b32 v94, v170, v166, s29
    v_perm_b32 v95, v178, v174, s29
    v_mfma_f32_4x4x4_16b_bf16 v[68:71], v[20:21], v[92:93], v[68:71] cbsz:3 abid:5
    v_perm_b32 v96, v171, v167, s28
    v_perm_b32 v97, v179, v175, s28
    v_mfma_f32_4x4x4_16b_bf16 v[72:75], v[20:21], v[94:95], v[72:75] cbsz:3 abid:5
    v_perm_b32 v98, v171, v167, s29
    v_perm_b32 v99, v179, v175, s29
    v_mfma_f32_4x4x4_16b_bf16 v[76:79], v[20:21], v[96:97], v[76:79] cbsz:3 abid:5
    s_nop 0
    v_mfma_f32_4x4x4_16b_bf16 v[80:83], v[20:21], v[98:99], v[80:83] cbsz:3 abid:5
    s_waitcnt vmcnt(7)
    buffer_load_dwordx4 v[232:235], v3, s[20:23], s25 offen offset:1024 nt
    s_waitcnt vmcnt(7)
    buffer_load_dwordx4 v[236:239], v2, s[20:23], s25 offen offset:3072 nt
    s_waitcnt vmcnt(7)
    buffer_load_dwordx4 v[240:243], v3, s[20:23], s25 offen offset:3072 nt
    s_add_u32 s25, s25, 65536
    s_waitcnt vmcnt(12)
    v_perm_b32 v92, v184, v180, s28
    v_perm_b32 v93, v192, v188, s28
    v_perm_b32 v94, v184, v180, s29
    v_perm_b32 v95, v192, v188, s29
    v_mfma_f32_4x4x4_16b_bf16 v[52:55], v[20:21], v[92:93], v[52:55] cbsz:3 abid:2
    v_perm_b32 v96, v185, v181, s28
    v_perm_b32 v97, v193, v189, s28
    v_mfma_f32_4x4x4_16b_bf16 v[56:59], v[20:21], v[94:95], v[56:59] cbsz:3 abid:2
    v_perm_b32 v98, v185, v181, s29
    v_perm_b32 v99, v193, v189, s29
    v_mfma_f32_4x4x4_16b_bf16 v[60:63], v[20:21], v[96:97], v[60:63] cbsz:3 abid:2
    s_nop 0
    v_mfma_f32_4x4x4_16b_bf16 v[64:67], v[20:21], v[98:99], v[64:67] cbsz:3 abid:2
    v_perm_b32 v92, v186, v182, s28
    v_perm_b32 v93, v194, v190, s28
    v_perm_b32 v94, v186, v182, s29
    v_perm_b32 v95, v194, v190, s29
    v_mfma_f32_4x4x4_16b_bf16 v[68:71], v[20:21], v[92:93], v[68:71] cbsz:3 abid:2
    v_perm_b32 v96, v187, v183, s28
    v_perm_b32 v97, v195, v191, s28
    v_mfma_f32_4x4x4_16b_bf16 v[72:75], v[20:21], v[94:95], v[72:75] cbsz:3 abid:2
    v_perm_b32 v98, v187, v183, s29
    v_perm_b32 v99, v195, v191, s29
    v_mfma_f32_4x4x4_16b_bf16 v[76:79], v[20:21], v[96:97], v[76:79] cbsz:3 abid:2
    s_nop 0
    v_mfma_f32_4x4x4_16b_bf16 v[80:83], v[20:21], v[98:99], v[80:83] cbsz:3 abid:2
    s_waitcnt vmcnt(8)
    v_perm_b32 v92, v200, v196, s28
    v_perm_b32 v93, v208, v204, s28
    v_perm_b32 v94, v200, v196, s29
    v_perm_b32 v95, v208, v204, s29
    v_mfma_f32_4x4x4_16b_bf16 v[52:55], v[20:21], v[92:93], v[52:55] cbsz:3 abid:6
    v_perm_b32 v96, v201, v197, s28
    v_perm_b32 v97, v209, v205, s28
    v_mfma_f32_4x4x4_16b_bf16 v[56:59], v[20:21], v[94:95], v[56:59] cbsz:3 abid:6
    v_perm_b32 v98, v201, v197, s29
    v_perm_b32 v99, v209, v205, s29
    v_mfma_f32_4x4x4_16b_bf16 v[60:63], v[20:21], v[96:97], v[60:63] cbsz:3 abid:6
    v_perm_b32 v92, v202, v198, s28
    v_perm_b32 v93, v210, v206, s28
    v_mfma_f32_4x4x4_16b_bf16 v[64:67], v[20:21], v[98:99], v[64:67] cbsz:3 abid:6
    v_perm_b32 v94, v202, v198, s29
    v_perm_b32 v95, v210, v206, s29
    v_mfma_f32_4x4x4_16b_bf16 v[68:71], v[20:21], v[92:93], v[68:71] cbsz:3 abid:6
    v_perm_b32 v96, v203, v199, s28
    v_perm_b32 v97, v211, v207, s28
    v_mfma_f32_4x4x4_16b_bf16 v[72:75], v[20:21], v[94:95], v[72:75] cbsz:3 abid:6
    v_perm_b32 v98, v203, v199, s29
    v_perm_b32 v99, v211, v207, s29
    v_mfma_f32_4x4x4_16b_bf16 v[76:79], v[20:21], v[96:97], v[76:79] cbsz:3 abid:6
    s_nop 0
    v_mfma_f32_4x4x4_16b_bf16 v[80:83], v[20:21], v[98:99], v[80:83] cbsz:3 abid:6
    s_waitcnt vmcnt(4)
    v_perm_b32 v92, v216, v212, s28
    v_perm_b32 v93, v224, v220, s28
    v_perm_b32 v94, v216, v212, s29
    v_perm_b32 v95, v224, v220, s29
    v_mfma_f32_4x4x4_16b_bf16 v[52:55], v[20:21], v[92:93], v[52:55] cbsz:3 abid:3
    v_perm_b32 v96, v217, v213, s28
    v_perm_b32 v97, v225, v221, s28
    v_mfma_f32_4x4x4_16b_bf16 v[56:59], v[20:21], v[94:95], v[56:59] cbsz:3 abid:3
    v_perm_b32 v98, v217, v213, s29
    v_perm_b32 v99, v225, v221, s29
    v_mfma_f32_4x4x4_16b_bf16 v[60:63], v[20:21], v[96:97], v[60:63] cbsz:3 abid:3
    s_nop 0
    v_mfma_f32_4x4x4_16b_bf16 v[64:67], v[20:21], v[98:99], v[64:67] cbsz:3 abid:3
    v_perm_b32 v92, v218, v214, s28
    v_perm_b32 v93, v226, v222, s28
    v_perm_b32 v94, v218, v214, s29
    v_perm_b32 v95, v226, v222, s29
    v_mfma_f32_4x4x4_16b_bf16 v[68:71], v[20:21], v[92:93], v[68:71] cbsz:3 abid:3
    v_perm_b32 v96, v219, v215, s28
    v_perm_b32 v97, v227, v223, s28
    v_mfma_f32_4x4x4_16b_bf16 v[72:75], v[20:21], v[94:95], v[72:75] cbsz:3 abid:3
    v_perm_b32 v98, v219, v215, s29
    v_perm_b32 v99, v227, v223, s29
    v_mfma_f32_4x4x4_16b_bf16 v[76:79], v[20:21], v[96:97], v[76:79] cbsz:3 abid:3
    s_nop 0
    v_mfma_f32_4x4x4_16b_bf16 v[80:83], v[20:21], v[98:99], v[80:83] cbsz:3 abid:3
    global_load_dwordx4 v[140:143], v109, s[14:15] sc1
    global_load_dwordx4 v[144:147], v113, s[14:15] offset:1024 sc1
    s_waitcnt vmcnt(2)
    v_perm_b32 v92, v232, v228, s28
    v_perm_b32 v93, v240, v236, s28
    v_perm_b32 v94, v232, v228, s29
    v_perm_b32 v95, v240, v236, s29
    v_mfma_f32_4x4x4_16b_bf16 v[52:55], v[20:21], v[92:93], v[52:55] cbsz:3 abid:7
    v_perm_b32 v96, v233, v229, s28
    v_perm_b32 v97, v241, v237, s28
    v_mfma_f32_4x4x4_16b_bf16 v[56:59], v[20:21], v[94:95], v[56:59] cbsz:3 abid:7
    v_perm_b32 v98, v233, v229, s29
    v_perm_b32 v99, v241, v237, s29
    v_mfma_f32_4x4x4_16b_bf16 v[60:63], v[20:21], v[96:97], v[60:63] cbsz:3 abid:7
    v_perm_b32 v92, v234, v230, s28
    v_perm_b32 v93, v242, v238, s28
    v_mfma_f32_4x4x4_16b_bf16 v[64:67], v[20:21], v[98:99], v[64:67] cbsz:3 abid:7
    v_perm_b32 v94, v234, v230, s29
    v_perm_b32 v95, v242, v238, s29
    v_mfma_f32_4x4x4_16b_bf16 v[68:71], v[20:21], v[92:93], v[68:71] cbsz:3 abid:7
    v_perm_b32 v96, v235, v231, s28
    v_perm_b32 v97, v243, v239, s28
    v_mfma_f32_4x4x4_16b_bf16 v[72:75], v[20:21], v[94:95], v[72:75] cbsz:3 abid:7
    v_perm_b32 v98, v235, v231, s29
    v_perm_b32 v99, v243, v239, s29
    v_mfma_f32_4x4x4_16b_bf16 v[76:79], v[20:21], v[96:97], v[76:79] cbsz:3 abid:7
    s_nop 0
    v_mfma_f32_4x4x4_16b_bf16 v[80:83], v[20:21], v[98:99], v[80:83] cbsz:3 abid:7
    v_permlane32_swap_b32 v52, v68
    v_permlane32_swap_b32 v56, v72
    s_nop 0
    v_permlane32_swap_b32 v60, v76
    s_nop 0
    v_permlane32_swap_b32 v64, v80
    v_add_f32 v116, v52, v68
    v_add_f32 v117, v56, v72
    v_add_f32 v118, v60, v76
    v_add_f32 v119, v64, v80
    ds_write_b128 v111, v[116:119] offset:0
    v_permlane32_swap_b32 v53, v69
    v_permlane32_swap_b32 v57, v73
    v_permlane32_swap_b32 v61, v77
    v_permlane32_swap_b32 v65, v81
    v_add_f32 v120, v53, v69
    v_add_f32 v121, v57, v73
    v_add_f32 v122, v61, v77
    v_add_f32 v123, v65, v81
    ds_write_b128 v111, v[120:123] offset:1024
    v_permlane32_swap_b32 v54, v70
    v_permlane32_swap_b32 v58, v74
    v_permlane32_swap_b32 v62, v78
    v_permlane32_swap_b32 v66, v82
    v_add_f32 v124, v54, v70
    v_add_f32 v125, v58, v74
    v_add_f32 v126, v62, v78
    v_add_f32 v127, v66, v82
    ds_write_b128 v111, v[124:127] offset:2048
    v_permlane32_swap_b32 v55, v71
    v_permlane32_swap_b32 v59, v75
    v_permlane32_swap_b32 v63, v79
    v_permlane32_swap_b32 v67, v83
    v_add_f32 v128, v55, v71
    v_add_f32 v129, v59, v75
    v_add_f32 v130, v63, v79
    v_add_f32 v131, v67, v83
    ds_write_b128 v111, v[128:131] offset:3072
    s_lshl_b32 s3, s30, 5
    s_add_u32 s3, s3, 16384
    v_mov_b32 v103, s3
    s_waitcnt lgkmcnt(0)
    s_barrier
    global_load_dwordx4 v[148:151], v109, s[14:15] sc1
    global_load_dwordx4 v[152:155], v113, s[14:15] offset:1024 sc1
    ds_read_b128 v[132:135], v103
    ds_read_b128 v[136:139], v103 offset:16
    ds_read_b128 v[116:119], v105 offset:0
    ds_read_b128 v[120:123], v105 offset:4096
    ds_read_b128 v[124:127], v105 offset:8192
    ds_read_b128 v[128:131], v105 offset:12288
    s_waitcnt lgkmcnt(4)
    v_max3_f32 v100, v132, v134, v136
    v_max_f32 v100, v100, v138
    v_sub_f32 v132, v132, v100
    v_sub_f32 v134, v134, v100
    v_sub_f32 v136, v136, v100
    v_sub_f32 v138, v138, v100
    v_mul_f32 v132, s27, v132
    v_mul_f32 v134, s27, v134
    v_mul_f32 v136, s27, v136
    v_mul_f32 v138, s27, v138
    v_exp_f32 v132, v132
    v_exp_f32 v134, v134
    v_exp_f32 v136, v136
    v_exp_f32 v138, v138
    v_mul_f32 v101, v132, v133
    v_fma_f32 v101, v134, v135, v101
    v_fma_f32 v101, v136, v137, v101
    v_fma_f32 v101, v138, v139, v101
    s_waitcnt lgkmcnt(0)
    v_mul_f32 v52, v132, v116
    v_mul_f32 v53, v132, v117
    v_mul_f32 v54, v132, v118
    v_mul_f32 v55, v132, v119
    v_fma_f32 v52, v134, v120, v52
    v_fma_f32 v53, v134, v121, v53
    v_fma_f32 v54, v134, v122, v54
    v_fma_f32 v55, v134, v123, v55
    v_fma_f32 v52, v136, v124, v52
    v_fma_f32 v53, v136, v125, v53
    v_fma_f32 v54, v136, v126, v54
    v_fma_f32 v55, v136, v127, v55
    v_fma_f32 v52, v138, v128, v52
    v_fma_f32 v53, v138, v129, v53
    v_fma_f32 v54, v138, v130, v54
    v_fma_f32 v55, v138, v131, v55
    s_waitcnt vmcnt(2)
    v_xor_b32 v102, v143, v106
    v_xor_b32 v103, v147, v106
    v_or_b32 v102, v102, v103
    v_cmp_ne_u32 vcc, 0, v102
    s_cbranch_vccz L_cmb
    v_perm_b32 v116, v53, v52, s44
    v_perm_b32 v117, v54, v53, s45
    v_perm_b32 v118, v55, v54, s46
    v_mov_b32 v119, v106
    v_mov_b32 v120, v106
    v_mov_b32 v121, v100
    v_mov_b32 v122, v101
    v_mov_b32 v123, v106
    global_store_dwordx4 v107, v[116:119], s[14:15] sc1
    s_mov_b64 exec, 1
    global_store_dwordx4 v112, v[120:123], s[14:15] offset:1024 sc1
    s_mov_b64 exec, -1
    s_waitcnt vmcnt(2)
    v_xor_b32 v102, v151, v106
    v_xor_b32 v103, v155, v106
    v_or_b32 v102, v102, v103
    v_cmp_ne_u32 vcc, 0, v102
    s_cbranch_vccnz L_n130
    v_mov_b32 v140, v148
    v_mov_b32 v141, v149
    v_mov_b32 v142, v150
    v_mov_b32 v143, v151
    v_mov_b32 v144, v152
    v_mov_b32 v145, v153
    v_mov_b32 v146, v154
    v_mov_b32 v147, v155
    s_branch L_cmb
L_n130:
    global_load_dwordx4 v[140:143], v109, s[14:15] sc1
    global_load_dwordx4 v[144:147], v113, s[14:15] offset:1024 sc1
    s_waitcnt vmcnt(0)
    v_xor_b32 v102, v143, v106
    v_xor_b32 v103, v147, v106
    v_or_b32 v102, v102, v103
    v_cmp_ne_u32 vcc, 0, v102
    s_cbranch_vccz L_cmb
    global_load_dwordx4 v[140:143], v109, s[14:15] sc1
    global_load_dwordx4 v[144:147], v113, s[14:15] offset:1024 sc1
    s_waitcnt vmcnt(0)
    v_xor_b32 v102, v143, v106
    v_xor_b32 v103, v147, v106
    v_or_b32 v102, v102, v103
    v_cmp_ne_u32 vcc, 0, v102
    s_cbranch_vccnz L_fin
L_cmb:
    v_max_f32 v103, v100, v145
    v_sub_f32 v100, v100, v103
    v_sub_f32 v145, v145, v103
    v_mul_f32 v100, s27, v100
    v_mul_f32 v145, s27, v145
    v_exp_f32 v100, v100
    v_exp_f32 v145, v145
    v_lshlrev_b32 v116, 8, v140
    v_perm_b32 v117, v141, v140, s47
    v_mul_f32 v101, v101, v100
    v_mul_f32 v146, v146, v145
    v_perm_b32 v118, v142, v141, s48
    v_add_f32 v101, v101, v146
    v_and_b32 v119, s49, v142
    v_rcp_f32 v101, v101
    v_and_b32 v52, s49, v52
    v_and_b32 v53, s49, v53
    v_and_b32 v54, s49, v54
    v_and_b32 v55, s49, v55
    v_mul_f32 v100, v100, v101
    v_mul_f32 v145, v145, v101
    v_mul_f32 v52, v52, v100
    v_mul_f32 v116, v116, v145
    v_mul_f32 v53, v53, v100
    v_mul_f32 v117, v117, v145
    v_mul_f32 v54, v54, v100
    v_mul_f32 v118, v118, v145
    v_mul_f32 v55, v55, v100
    v_mul_f32 v119, v119, v145
    v_add_f32 v52, v52, v116
    v_add_f32 v53, v53, v117
    v_add_f32 v54, v54, v118
    v_add_f32 v55, v55, v119
    v_cvt_pk_bf16_f32 v52, v52, v53
    v_cvt_pk_bf16_f32 v53, v54, v55
    global_store_dwordx2 v110, v[52:53], s[10:11] nt
    s_mov_b64 exec, 1
    global_store_dword v108, v106, s[14:15] sc1
    s_mov_b64 exec, -1
L_fin:
L_end:
    s_endpgm
.section .rodata,"a"
.p2align 6
.amdhsa_kernel standalone__mha_softmax__sampling_kernel
  .amdhsa_next_free_vgpr 244
  .amdhsa_next_free_sgpr 56
  .amdhsa_accum_offset 244
  .amdhsa_group_segment_fixed_size 0
  .amdhsa_kernarg_size 48
  .amdhsa_user_sgpr_count 2
  .amdhsa_user_sgpr_kernarg_segment_ptr 1
  .amdhsa_system_sgpr_workgroup_id_x 1
.end_amdhsa_kernel
```
